```python
import torch

def _softmax(x, axis=-1):
    return torch.softmax(x, dim=axis)
def _gelu(x):
    return torch.nn.functional.gelu(x, approximate="tanh")
def _silu(x):
    return torch.nn.functional.silu(x)
def _sigmoid(x):
    return torch.sigmoid(x)
def _layernorm(x, axis=-1, eps=1e-5):
    m = x.mean(dim=axis, keepdim=True)
    v = x.var(dim=axis, keepdim=True, unbiased=False)
    return (x - m) / torch.sqrt(v + eps)
def _scatter_add(tgt, idx, src, axis=0):
    return tgt.clone().index_add_(axis, idx, src)
def _segment_sum(src, seg, n):
    out = torch.zeros((n,) + src.shape[1:], dtype=src.dtype)
    return out.index_add_(0, seg, src)
def _pad(x, pw):
    flat = tuple(v for pair in reversed(pw) for v in pair)
    return torch.nn.functional.pad(x, flat)

kernel_name = 'standalone__controlnet__diffusion'

def setup_inputs():

    _w = (lambda a: (lambda t: t.to(torch.bfloat16) if t.is_floating_point() else t)(torch.as_tensor(a)))
    B, HW, C = 2, 64, 512
    sc = C ** -0.5
    return {
        "x_frozen": _w((lambda *s: torch.randn(*s, dtype=torch.bfloat16) * 0.1)(B, HW, HW, C)),
        "x": _w((lambda *s: torch.randn(*s, dtype=torch.bfloat16) * 0.2)(B, HW, HW, C)),
        "c": _w((lambda *s: torch.randn(*s, dtype=torch.bfloat16) * 0.8)(B, HW, HW, C)),
        "w_z1": _w((lambda *s: torch.randn(*s, dtype=torch.bfloat16) * 0.8)(C, C) * sc),
        "w_z2": _w((lambda *s: torch.randn(*s, dtype=torch.bfloat16) * 0.2)(C, C) * sc),
        "w_conv": _w((lambda *s: torch.randn(*s, dtype=torch.bfloat16) * 0.2)(3, 3, C, C) * sc / 3.0),
    }

def reference(x_frozen, x, c, w_z1, w_z2, w_conv):
    B, H, W, C = x.shape
    h_in = x + torch.einsum("bhwc,cd->bhwd", c, w_z1)
    h = _silu(_layernorm(h_in, axis=-1))
    hp = _pad(h, ((0, 0), (1, 1), (1, 1), (0, 0)))
    acc = h * 0.0
    for di in range(3):
        for dj in range(3):
            acc = acc + torch.einsum("bhwc,cd->bhwd", hp[:, di:di + H, dj:dj + W, :], w_conv[di, dj])
    h = h_in + acc
    return x_frozen + torch.einsum("bhwc,cd->bhwd", h, w_z2)
```

```asm
; @launch kernel=cn_k1_kernel grid=(256,1,1) block=(512,1,1) lds=163840
; @launch kernel=cn_k2_kernel grid=(256,1,1) block=(256,1,1) lds=131072
.amdgcn_target "amdgcn-amd-amdhsa--gfx950"
.text
.globl cn_k1_kernel
.p2align 8
.type cn_k1_kernel,@function
cn_k1_kernel:
s_cmp_ge_u32 s2, 256
s_cbranch_scc1 cn_k1_kernel_end
s_load_dwordx2 s[20:21], s[0:1], 64
s_load_dwordx2 s[12:13], s[0:1], 8
s_getpc_b64 s[74:75]
cn_k1_kernel_pc:
s_lshr_b32 s73, s2, 3
s_mul_i32 s73, s73, 1024
v_lshl_add_u32 v2, v0, 7, s73
v_min_u32 v2, cn_code_end-cn_k1_kernel_pc-4, v2
v_cmp_gt_u32 vcc, 8, v0
s_and_saveexec_b64 s[72:73], vcc
s_cbranch_execz cn_k1_kernel_nic
global_load_dword v215, v2, s[74:75]
cn_k1_kernel_nic:
s_mov_b64 exec, s[72:73]
v_lshrrev_b32 v1, 6, v0
s_and_b32 s26, s2, 7
v_readfirstlane_b32 s24, v1
s_lshr_b32 s25, s2, 3
s_xor_b32 s24, s24, 4
v_and_b32 v1, 63, v0
s_mov_b32 s22, 0x10000000
s_mov_b32 s23, 0x20000
s_mov_b32 s14, 8388608
s_mov_b32 s15, 0x20000
s_cmp_ge_u32 s25, 28
s_cbranch_scc1 cn_k1_kernel_pf
s_cmp_ge_u32 s25, 16
s_cbranch_scc1 cn_k1_kernel_c
s_load_dwordx2 s[4:5], s[0:1], 16
s_load_dwordx2 s[8:9], s[0:1], 24
s_load_dwordx2 s[16:17], s[0:1], 0
s_lshl_b32 s28, s26, 4
s_add_u32 s28, s28, s25
s_mov_b32 s6, 8388608
s_mov_b32 s7, 0x20000
s_mov_b32 s10, 524288
s_mov_b32 s11, 0x20000
s_mov_b32 s18, 8388608
s_mov_b32 s19, 0x20000
v_lshrrev_b32 v136, 3, v1
v_and_b32 v137, 7, v1
v_lshrrev_b32 v138, 4, v1
v_xor_b32 v139, v137, v138
v_lshlrev_b32 v2, 11, v136
v_lshl_add_u32 v2, v139, 4, v2
v_xor_b32 v3, 64, v2
v_add_u32 v3, 16384, v3
s_lshl_b32 s38, s28, 16
s_lshl_b32 s36, s24, 7
s_add_u32 s31, s38, s36
s_mul_i32 s33, s24, 12288
s_add_u32 s33, s33, 65536
s_and_b32 s37, s24, 3
s_lshr_b32 s39, s24, 2
s_lshl_b32 s32, s37, 13
s_lshl_b32 s40, s39, 12
s_add_u32 s32, s32, s40
s_lshl_b32 s34, s37, 7
s_lshl_b32 s40, s39, 15
s_add_u32 s34, s34, s40
s_add_u32 s34, s34, s38
v_and_b32 v139, 1, v138
v_lshlrev_b32 v139, 1, v139
v_xor_b32 v139, v139, v137
v_lshlrev_b32 v4, 10, v136
v_lshl_add_u32 v4, v139, 4, v4
v_add_u32 v4, s36, v4
v_xor_b32 v5, 64, v4
v_add_u32 v5, 7168, v5
v_add_u32 v6, 14336, v4
v_add_u32 v7, 14336, v5
s_and_b32 s37, s24, 1
s_lshr_b32 s39, s24, 1
s_lshl_b32 s29, s37, 13
s_lshl_b32 s40, s39, 11
s_add_u32 s29, s29, s40
s_lshl_b32 s30, s37, 7
s_add_u32 s30, s30, s38
s_and_b32 s40, s39, 1
s_lshl_b32 s40, s40, 10
s_add_u32 s30, s30, s40
s_lshr_b32 s40, s39, 1
s_lshl_b32 s40, s40, 15
s_add_u32 s30, s30, s40
s_waitcnt lgkmcnt(0)
s_setprio 1
s_add_u32 m0, s29, 0
s_add_u32 s37, s30, 0
buffer_load_dwordx4 v2, s[4:7], s37 offen lds
s_add_u32 m0, s29, 1024
s_add_u32 s37, s30, 0
buffer_load_dwordx4 v3, s[4:7], s37 offen lds
s_barrier
s_add_u32 m0, s33, 0
s_mov_b32 s35, 0
buffer_load_dwordx4 v4, s[8:11], s35 offen offset:0 lds
buffer_load_dwordx4 v5, s[8:11], s35 offen offset:1024 lds
buffer_load_dwordx4 v6, s[8:11], s35 offen offset:2048 lds
buffer_load_dwordx4 v7, s[8:11], s35 offen offset:3072 lds
v_and_b32 v136, 15, v1
v_lshrrev_b32 v137, 1, v136
v_xor_b32 v137, v137, v138
v_lshlrev_b32 v12, 7, v136
v_lshl_add_u32 v12, v137, 4, v12
v_xor_b32 v13, 64, v12
v_add_u32 v14, s33, v12
v_add_u32 v15, s33, v13
v_lshrrev_b32 v137, 2, v136
v_lshl_add_u32 v139, v138, 3, v137
v_lshlrev_b32 v8, 7, v139
v_and_b32 v139, 3, v136
v_lshl_add_u32 v8, v139, 3, v8
v_lshrrev_b32 v137, 1, v137
v_and_b32 v139, 1, v138
v_lshl_add_u32 v137, v139, 1, v137
v_lshl_add_u32 v8, v137, 5, v8
v_add_u32 v8, s33, v8
v_xor_b32 v9, 32, v8
v_xor_b32 v10, 64, v8
v_xor_b32 v11, 96, v8
v_lshrrev_b32 v137, 3, v136
v_sub_u32 v137, v138, v137
v_bfe_u32 v139, v136, 1, 2
v_lshl_add_u32 v137, v137, 2, v139
v_and_b32 v139, 1, v136
v_lshlrev_b32 v139, 4, v139
v_mov_b32 v136, 0x3f80
v_lshlrev_b32 v139, v139, v136
v_cmp_eq_u32 vcc, 0, v137
s_nop 1
v_cndmask_b32 v128, 0, v139, vcc
v_cmp_eq_u32 vcc, 1, v137
s_nop 1
v_cndmask_b32 v129, 0, v139, vcc
v_cmp_eq_u32 vcc, 2, v137
s_nop 1
v_cndmask_b32 v130, 0, v139, vcc
v_cmp_eq_u32 vcc, 3, v137
s_nop 1
v_cndmask_b32 v131, 0, v139, vcc
v_cmp_eq_u32 vcc, 8, v137
s_nop 1
v_cndmask_b32 v132, 0, v139, vcc
v_cmp_eq_u32 vcc, 9, v137
s_nop 1
v_cndmask_b32 v133, 0, v139, vcc
v_cmp_eq_u32 vcc, 10, v137
s_nop 1
v_cndmask_b32 v134, 0, v139, vcc
v_cmp_eq_u32 vcc, 11, v137
s_nop 1
v_cndmask_b32 v135, 0, v139, vcc
s_waitcnt vmcnt(4)
s_barrier
s_add_u32 m0, s33, 4096
s_mov_b32 s35, 32768
buffer_load_dwordx4 v4, s[8:11], s35 offen offset:0 lds
buffer_load_dwordx4 v5, s[8:11], s35 offen offset:1024 lds
buffer_load_dwordx4 v6, s[8:11], s35 offen offset:2048 lds
buffer_load_dwordx4 v7, s[8:11], s35 offen offset:3072 lds
ds_read_b128 v[112:115], v12 offset:0
ds_read_b128 v[116:119], v12 offset:2048
ds_read_b128 v[120:123], v12 offset:4096
ds_read_b128 v[124:127], v12 offset:6144
s_waitcnt vmcnt(4)
ds_read_b64_tr_b16 v[80:81], v8 offset:0
ds_read_b64_tr_b16 v[82:83], v8 offset:512
ds_read_b64_tr_b16 v[84:85], v9 offset:0
ds_read_b64_tr_b16 v[86:87], v9 offset:512
ds_read_b64_tr_b16 v[88:89], v10 offset:0
ds_read_b64_tr_b16 v[90:91], v10 offset:512
ds_read_b64_tr_b16 v[92:93], v11 offset:0
ds_read_b64_tr_b16 v[94:95], v11 offset:512
s_add_u32 m0, s33, 8192
s_mov_b32 s35, 65536
buffer_load_dwordx4 v4, s[8:11], s35 offen offset:0 lds
buffer_load_dwordx4 v5, s[8:11], s35 offen offset:1024 lds
buffer_load_dwordx4 v6, s[8:11], s35 offen offset:2048 lds
buffer_load_dwordx4 v7, s[8:11], s35 offen offset:3072 lds
s_waitcnt lgkmcnt(0)
v_mfma_f32_16x16x32_bf16 v[16:19], v[80:83], v[112:115], 0
s_add_u32 m0, s33, 0
s_mov_b32 s35, 98304
v_mfma_f32_16x16x32_bf16 v[32:35], v[84:87], v[112:115], 0
buffer_load_dwordx4 v4, s[8:11], s35 offen offset:0 lds
buffer_load_dwordx4 v5, s[8:11], s35 offen offset:1024 lds
v_mfma_f32_16x16x32_bf16 v[48:51], v[88:91], v[112:115], 0
buffer_load_dwordx4 v6, s[8:11], s35 offen offset:2048 lds
v_mfma_f32_16x16x32_bf16 v[64:67], v[92:95], v[112:115], 0
buffer_load_dwordx4 v7, s[8:11], s35 offen offset:3072 lds
s_waitcnt lgkmcnt(10)
v_mfma_f32_16x16x32_bf16 v[20:23], v[80:83], v[116:119], 0
ds_read_b128 v[112:115], v13 offset:0
v_mfma_f32_16x16x32_bf16 v[36:39], v[84:87], v[116:119], 0
s_waitcnt vmcnt(8)
ds_read_b64_tr_b16 v[96:97], v8 offset:4096
v_mfma_f32_16x16x32_bf16 v[52:55], v[88:91], v[116:119], 0
ds_read_b64_tr_b16 v[98:99], v8 offset:4608
v_mfma_f32_16x16x32_bf16 v[68:71], v[92:95], v[116:119], 0
ds_read_b64_tr_b16 v[100:101], v9 offset:4096
s_waitcnt lgkmcnt(13)
v_mfma_f32_16x16x32_bf16 v[24:27], v[80:83], v[120:123], 0
ds_read_b128 v[116:119], v13 offset:2048
ds_read_b64_tr_b16 v[102:103], v9 offset:4608
v_mfma_f32_16x16x32_bf16 v[40:43], v[84:87], v[120:123], 0
ds_read_b64_tr_b16 v[104:105], v10 offset:4096
v_mfma_f32_16x16x32_bf16 v[56:59], v[88:91], v[120:123], 0
ds_read_b64_tr_b16 v[106:107], v10 offset:4608
v_mfma_f32_16x16x32_bf16 v[72:75], v[92:95], v[120:123], 0
ds_read_b64_tr_b16 v[108:109], v11 offset:4096
s_waitcnt lgkmcnt(15)
v_mfma_f32_16x16x32_bf16 v[28:31], v[80:83], v[124:127], 0
ds_read_b128 v[120:123], v13 offset:4096
ds_read_b64_tr_b16 v[110:111], v11 offset:4608
v_mfma_f32_16x16x32_bf16 v[44:47], v[84:87], v[124:127], 0
v_mfma_f32_16x16x32_bf16 v[60:63], v[88:91], v[124:127], 0
v_mfma_f32_16x16x32_bf16 v[76:79], v[92:95], v[124:127], 0
ds_read_b128 v[124:127], v13 offset:6144
s_waitcnt lgkmcnt(1)
v_mfma_f32_16x16x32_bf16 v[16:19], v[96:99], v[112:115], v[16:19]
s_add_u32 m0, s29, 16384
s_add_u32 s37, s30, 256
v_mfma_f32_16x16x32_bf16 v[32:35], v[100:103], v[112:115], v[32:35]
buffer_load_dwordx4 v2, s[4:7], s37 offen lds
s_add_u32 m0, s29, 17408
v_mfma_f32_16x16x32_bf16 v[48:51], v[104:107], v[112:115], v[48:51]
s_add_u32 s37, s30, 256
buffer_load_dwordx4 v3, s[4:7], s37 offen lds
s_add_u32 m0, s33, 4096
v_mfma_f32_16x16x32_bf16 v[64:67], v[108:111], v[112:115], v[64:67]
s_mov_b32 s35, 131072
buffer_load_dwordx4 v4, s[8:11], s35 offen offset:0 lds
buffer_load_dwordx4 v5, s[8:11], s35 offen offset:1024 lds
s_waitcnt lgkmcnt(7)
v_mfma_f32_16x16x32_bf16 v[20:23], v[96:99], v[116:119], v[20:23]
buffer_load_dwordx4 v6, s[8:11], s35 offen offset:2048 lds
buffer_load_dwordx4 v7, s[8:11], s35 offen offset:3072 lds
ds_read_b128 v[112:115], v12 offset:8192
v_mfma_f32_16x16x32_bf16 v[36:39], v[100:103], v[116:119], v[36:39]
s_waitcnt vmcnt(10)
ds_read_b64_tr_b16 v[80:81], v8 offset:8192
v_mfma_f32_16x16x32_bf16 v[52:55], v[104:107], v[116:119], v[52:55]
ds_read_b64_tr_b16 v[82:83], v8 offset:8704
v_mfma_f32_16x16x32_bf16 v[68:71], v[108:111], v[116:119], v[68:71]
ds_read_b64_tr_b16 v[84:85], v9 offset:8192
s_waitcnt lgkmcnt(6)
v_mfma_f32_16x16x32_bf16 v[24:27], v[96:99], v[120:123], v[24:27]
ds_read_b128 v[116:119], v12 offset:10240
ds_read_b64_tr_b16 v[86:87], v9 offset:8704
v_mfma_f32_16x16x32_bf16 v[40:43], v[100:103], v[120:123], v[40:43]
ds_read_b64_tr_b16 v[88:89], v10 offset:8192
v_mfma_f32_16x16x32_bf16 v[56:59], v[104:107], v[120:123], v[56:59]
ds_read_b64_tr_b16 v[90:91], v10 offset:8704
v_mfma_f32_16x16x32_bf16 v[72:75], v[108:111], v[120:123], v[72:75]
ds_read_b64_tr_b16 v[92:93], v11 offset:8192
s_waitcnt lgkmcnt(9)
v_mfma_f32_16x16x32_bf16 v[28:31], v[96:99], v[124:127], v[28:31]
ds_read_b128 v[120:123], v12 offset:12288
ds_read_b64_tr_b16 v[94:95], v11 offset:8704
v_mfma_f32_16x16x32_bf16 v[44:47], v[100:103], v[124:127], v[44:47]
v_mfma_f32_16x16x32_bf16 v[60:63], v[104:107], v[124:127], v[60:63]
v_mfma_f32_16x16x32_bf16 v[76:79], v[108:111], v[124:127], v[76:79]
ds_read_b128 v[124:127], v12 offset:14336
s_waitcnt lgkmcnt(1)
v_mfma_f32_16x16x32_bf16 v[16:19], v[80:83], v[112:115], v[16:19]
s_add_u32 m0, s33, 8192
s_mov_b32 s35, 163840
v_mfma_f32_16x16x32_bf16 v[32:35], v[84:87], v[112:115], v[32:35]
buffer_load_dwordx4 v4, s[8:11], s35 offen offset:0 lds
buffer_load_dwordx4 v5, s[8:11], s35 offen offset:1024 lds
v_mfma_f32_16x16x32_bf16 v[48:51], v[88:91], v[112:115], v[48:51]
buffer_load_dwordx4 v6, s[8:11], s35 offen offset:2048 lds
v_mfma_f32_16x16x32_bf16 v[64:67], v[92:95], v[112:115], v[64:67]
buffer_load_dwordx4 v7, s[8:11], s35 offen offset:3072 lds
s_waitcnt lgkmcnt(7)
v_mfma_f32_16x16x32_bf16 v[20:23], v[80:83], v[116:119], v[20:23]
ds_read_b128 v[112:115], v13 offset:8192
v_mfma_f32_16x16x32_bf16 v[36:39], v[84:87], v[116:119], v[36:39]
s_waitcnt vmcnt(10)
ds_read_b64_tr_b16 v[96:97], v8 offset:0
v_mfma_f32_16x16x32_bf16 v[52:55], v[88:91], v[116:119], v[52:55]
ds_read_b64_tr_b16 v[98:99], v8 offset:512
v_mfma_f32_16x16x32_bf16 v[68:71], v[92:95], v[116:119], v[68:71]
ds_read_b64_tr_b16 v[100:101], v9 offset:0
s_waitcnt lgkmcnt(6)
v_mfma_f32_16x16x32_bf16 v[24:27], v[80:83], v[120:123], v[24:27]
ds_read_b128 v[116:119], v13 offset:10240
ds_read_b64_tr_b16 v[102:103], v9 offset:512
v_mfma_f32_16x16x32_bf16 v[40:43], v[84:87], v[120:123], v[40:43]
ds_read_b64_tr_b16 v[104:105], v10 offset:0
v_mfma_f32_16x16x32_bf16 v[56:59], v[88:91], v[120:123], v[56:59]
ds_read_b64_tr_b16 v[106:107], v10 offset:512
v_mfma_f32_16x16x32_bf16 v[72:75], v[92:95], v[120:123], v[72:75]
ds_read_b64_tr_b16 v[108:109], v11 offset:0
s_waitcnt lgkmcnt(9)
v_mfma_f32_16x16x32_bf16 v[28:31], v[80:83], v[124:127], v[28:31]
ds_read_b128 v[120:123], v13 offset:12288
ds_read_b64_tr_b16 v[110:111], v11 offset:512
v_mfma_f32_16x16x32_bf16 v[44:47], v[84:87], v[124:127], v[44:47]
v_mfma_f32_16x16x32_bf16 v[60:63], v[88:91], v[124:127], v[60:63]
v_mfma_f32_16x16x32_bf16 v[76:79], v[92:95], v[124:127], v[76:79]
ds_read_b128 v[124:127], v13 offset:14336
s_waitcnt vmcnt(8) lgkmcnt(1)
s_barrier
v_mfma_f32_16x16x32_bf16 v[16:19], v[96:99], v[112:115], v[16:19]
s_add_u32 m0, s33, 0
s_mov_b32 s35, 196608
v_mfma_f32_16x16x32_bf16 v[32:35], v[100:103], v[112:115], v[32:35]
buffer_load_dwordx4 v4, s[8:11], s35 offen offset:0 lds
buffer_load_dwordx4 v5, s[8:11], s35 offen offset:1024 lds
buffer_load_dwordx4 v6, s[8:11], s35 offen offset:2048 lds
v_mfma_f32_16x16x32_bf16 v[48:51], v[104:107], v[112:115], v[48:51]
buffer_load_dwordx4 v7, s[8:11], s35 offen offset:3072 lds
s_add_u32 m0, s32, 32768
s_add_u32 s37, s34, 512
buffer_load_dwordx4 v2, s[4:7], s37 offen lds
s_add_u32 m0, s32, 33792
v_mfma_f32_16x16x32_bf16 v[64:67], v[108:111], v[112:115], v[64:67]
s_add_u32 s37, s34, 512
buffer_load_dwordx4 v3, s[4:7], s37 offen lds
s_add_u32 m0, s32, 34816
s_add_u32 s37, s34, 1536
buffer_load_dwordx4 v2, s[4:7], s37 offen lds
s_waitcnt lgkmcnt(7)
v_mfma_f32_16x16x32_bf16 v[20:23], v[96:99], v[116:119], v[20:23]
s_add_u32 m0, s32, 35840
s_add_u32 s37, s34, 1536
buffer_load_dwordx4 v3, s[4:7], s37 offen lds
ds_read_b128 v[112:115], v12 offset:16384
v_mfma_f32_16x16x32_bf16 v[36:39], v[100:103], v[116:119], v[36:39]
s_waitcnt vmcnt(12)
ds_read_b64_tr_b16 v[80:81], v8 offset:4096
v_mfma_f32_16x16x32_bf16 v[52:55], v[104:107], v[116:119], v[52:55]
ds_read_b64_tr_b16 v[82:83], v8 offset:4608
v_mfma_f32_16x16x32_bf16 v[68:71], v[108:111], v[116:119], v[68:71]
ds_read_b64_tr_b16 v[84:85], v9 offset:4096
s_waitcnt lgkmcnt(6)
v_mfma_f32_16x16x32_bf16 v[24:27], v[96:99], v[120:123], v[24:27]
ds_read_b128 v[116:119], v12 offset:18432
ds_read_b64_tr_b16 v[86:87], v9 offset:4608
v_mfma_f32_16x16x32_bf16 v[40:43], v[100:103], v[120:123], v[40:43]
ds_read_b64_tr_b16 v[88:89], v10 offset:4096
v_mfma_f32_16x16x32_bf16 v[56:59], v[104:107], v[120:123], v[56:59]
ds_read_b64_tr_b16 v[90:91], v10 offset:4608
v_mfma_f32_16x16x32_bf16 v[72:75], v[108:111], v[120:123], v[72:75]
ds_read_b64_tr_b16 v[92:93], v11 offset:4096
s_waitcnt lgkmcnt(9)
v_mfma_f32_16x16x32_bf16 v[28:31], v[96:99], v[124:127], v[28:31]
ds_read_b128 v[120:123], v12 offset:20480
ds_read_b64_tr_b16 v[94:95], v11 offset:4608
v_mfma_f32_16x16x32_bf16 v[44:47], v[100:103], v[124:127], v[44:47]
v_mfma_f32_16x16x32_bf16 v[60:63], v[104:107], v[124:127], v[60:63]
v_mfma_f32_16x16x32_bf16 v[76:79], v[108:111], v[124:127], v[76:79]
ds_read_b128 v[124:127], v12 offset:22528
s_waitcnt lgkmcnt(1)
v_mfma_f32_16x16x32_bf16 v[16:19], v[80:83], v[112:115], v[16:19]
s_add_u32 m0, s33, 4096
s_mov_b32 s35, 229376
v_mfma_f32_16x16x32_bf16 v[32:35], v[84:87], v[112:115], v[32:35]
buffer_load_dwordx4 v4, s[8:11], s35 offen offset:0 lds
buffer_load_dwordx4 v5, s[8:11], s35 offen offset:1024 lds
v_mfma_f32_16x16x32_bf16 v[48:51], v[88:91], v[112:115], v[48:51]
buffer_load_dwordx4 v6, s[8:11], s35 offen offset:2048 lds
v_mfma_f32_16x16x32_bf16 v[64:67], v[92:95], v[112:115], v[64:67]
buffer_load_dwordx4 v7, s[8:11], s35 offen offset:3072 lds
s_waitcnt lgkmcnt(7)
v_mfma_f32_16x16x32_bf16 v[20:23], v[80:83], v[116:119], v[20:23]
ds_read_b128 v[112:115], v13 offset:16384
v_mfma_f32_16x16x32_bf16 v[36:39], v[84:87], v[116:119], v[36:39]
s_waitcnt vmcnt(12)
ds_read_b64_tr_b16 v[96:97], v8 offset:8192
v_mfma_f32_16x16x32_bf16 v[52:55], v[88:91], v[116:119], v[52:55]
ds_read_b64_tr_b16 v[98:99], v8 offset:8704
v_mfma_f32_16x16x32_bf16 v[68:71], v[92:95], v[116:119], v[68:71]
ds_read_b64_tr_b16 v[100:101], v9 offset:8192
s_waitcnt lgkmcnt(6)
v_mfma_f32_16x16x32_bf16 v[24:27], v[80:83], v[120:123], v[24:27]
ds_read_b128 v[116:119], v13 offset:18432
ds_read_b64_tr_b16 v[102:103], v9 offset:8704
v_mfma_f32_16x16x32_bf16 v[40:43], v[84:87], v[120:123], v[40:43]
ds_read_b64_tr_b16 v[104:105], v10 offset:8192
v_mfma_f32_16x16x32_bf16 v[56:59], v[88:91], v[120:123], v[56:59]
ds_read_b64_tr_b16 v[106:107], v10 offset:8704
v_mfma_f32_16x16x32_bf16 v[72:75], v[92:95], v[120:123], v[72:75]
ds_read_b64_tr_b16 v[108:109], v11 offset:8192
s_waitcnt lgkmcnt(9)
v_mfma_f32_16x16x32_bf16 v[28:31], v[80:83], v[124:127], v[28:31]
ds_read_b128 v[120:123], v13 offset:20480
ds_read_b64_tr_b16 v[110:111], v11 offset:8704
v_mfma_f32_16x16x32_bf16 v[44:47], v[84:87], v[124:127], v[44:47]
v_mfma_f32_16x16x32_bf16 v[60:63], v[88:91], v[124:127], v[60:63]
v_mfma_f32_16x16x32_bf16 v[76:79], v[92:95], v[124:127], v[76:79]
ds_read_b128 v[124:127], v13 offset:22528
s_waitcnt lgkmcnt(1)
v_mfma_f32_16x16x32_bf16 v[16:19], v[96:99], v[112:115], v[16:19]
s_add_u32 m0, s33, 8192
s_mov_b32 s35, 262144
v_mfma_f32_16x16x32_bf16 v[32:35], v[100:103], v[112:115], v[32:35]
buffer_load_dwordx4 v4, s[8:11], s35 offen offset:0 lds
buffer_load_dwordx4 v5, s[8:11], s35 offen offset:1024 lds
v_mfma_f32_16x16x32_bf16 v[48:51], v[104:107], v[112:115], v[48:51]
buffer_load_dwordx4 v6, s[8:11], s35 offen offset:2048 lds
v_mfma_f32_16x16x32_bf16 v[64:67], v[108:111], v[112:115], v[64:67]
buffer_load_dwordx4 v7, s[8:11], s35 offen offset:3072 lds
s_waitcnt lgkmcnt(7)
v_mfma_f32_16x16x32_bf16 v[20:23], v[96:99], v[116:119], v[20:23]
ds_read_b128 v[112:115], v12 offset:24576
v_mfma_f32_16x16x32_bf16 v[36:39], v[100:103], v[116:119], v[36:39]
s_waitcnt vmcnt(12)
ds_read_b64_tr_b16 v[80:81], v8 offset:0
v_mfma_f32_16x16x32_bf16 v[52:55], v[104:107], v[116:119], v[52:55]
ds_read_b64_tr_b16 v[82:83], v8 offset:512
v_mfma_f32_16x16x32_bf16 v[68:71], v[108:111], v[116:119], v[68:71]
ds_read_b64_tr_b16 v[84:85], v9 offset:0
s_waitcnt lgkmcnt(6)
v_mfma_f32_16x16x32_bf16 v[24:27], v[96:99], v[120:123], v[24:27]
ds_read_b128 v[116:119], v12 offset:26624
ds_read_b64_tr_b16 v[86:87], v9 offset:512
v_mfma_f32_16x16x32_bf16 v[40:43], v[100:103], v[120:123], v[40:43]
ds_read_b64_tr_b16 v[88:89], v10 offset:0
v_mfma_f32_16x16x32_bf16 v[56:59], v[104:107], v[120:123], v[56:59]
ds_read_b64_tr_b16 v[90:91], v10 offset:512
v_mfma_f32_16x16x32_bf16 v[72:75], v[108:111], v[120:123], v[72:75]
ds_read_b64_tr_b16 v[92:93], v11 offset:0
s_waitcnt lgkmcnt(9)
v_mfma_f32_16x16x32_bf16 v[28:31], v[96:99], v[124:127], v[28:31]
ds_read_b128 v[120:123], v12 offset:28672
ds_read_b64_tr_b16 v[94:95], v11 offset:512
v_mfma_f32_16x16x32_bf16 v[44:47], v[100:103], v[124:127], v[44:47]
v_mfma_f32_16x16x32_bf16 v[60:63], v[104:107], v[124:127], v[60:63]
v_mfma_f32_16x16x32_bf16 v[76:79], v[108:111], v[124:127], v[76:79]
ds_read_b128 v[124:127], v12 offset:30720
s_waitcnt lgkmcnt(1)
v_mfma_f32_16x16x32_bf16 v[16:19], v[80:83], v[112:115], v[16:19]
s_add_u32 m0, s33, 0
s_mov_b32 s35, 294912
v_mfma_f32_16x16x32_bf16 v[32:35], v[84:87], v[112:115], v[32:35]
buffer_load_dwordx4 v4, s[8:11], s35 offen offset:0 lds
buffer_load_dwordx4 v5, s[8:11], s35 offen offset:1024 lds
v_mfma_f32_16x16x32_bf16 v[48:51], v[88:91], v[112:115], v[48:51]
buffer_load_dwordx4 v6, s[8:11], s35 offen offset:2048 lds
v_mfma_f32_16x16x32_bf16 v[64:67], v[92:95], v[112:115], v[64:67]
buffer_load_dwordx4 v7, s[8:11], s35 offen offset:3072 lds
s_waitcnt lgkmcnt(7)
v_mfma_f32_16x16x32_bf16 v[20:23], v[80:83], v[116:119], v[20:23]
ds_read_b128 v[112:115], v13 offset:24576
v_mfma_f32_16x16x32_bf16 v[36:39], v[84:87], v[116:119], v[36:39]
s_waitcnt vmcnt(8)
ds_read_b64_tr_b16 v[96:97], v8 offset:4096
v_mfma_f32_16x16x32_bf16 v[52:55], v[88:91], v[116:119], v[52:55]
ds_read_b64_tr_b16 v[98:99], v8 offset:4608
v_mfma_f32_16x16x32_bf16 v[68:71], v[92:95], v[116:119], v[68:71]
ds_read_b64_tr_b16 v[100:101], v9 offset:4096
s_waitcnt lgkmcnt(6)
v_mfma_f32_16x16x32_bf16 v[24:27], v[80:83], v[120:123], v[24:27]
ds_read_b128 v[116:119], v13 offset:26624
ds_read_b64_tr_b16 v[102:103], v9 offset:4608
v_mfma_f32_16x16x32_bf16 v[40:43], v[84:87], v[120:123], v[40:43]
ds_read_b64_tr_b16 v[104:105], v10 offset:4096
v_mfma_f32_16x16x32_bf16 v[56:59], v[88:91], v[120:123], v[56:59]
ds_read_b64_tr_b16 v[106:107], v10 offset:4608
v_mfma_f32_16x16x32_bf16 v[72:75], v[92:95], v[120:123], v[72:75]
ds_read_b64_tr_b16 v[108:109], v11 offset:4096
s_waitcnt lgkmcnt(9)
v_mfma_f32_16x16x32_bf16 v[28:31], v[80:83], v[124:127], v[28:31]
ds_read_b128 v[120:123], v13 offset:28672
ds_read_b64_tr_b16 v[110:111], v11 offset:4608
v_mfma_f32_16x16x32_bf16 v[44:47], v[84:87], v[124:127], v[44:47]
v_mfma_f32_16x16x32_bf16 v[60:63], v[88:91], v[124:127], v[60:63]
v_mfma_f32_16x16x32_bf16 v[76:79], v[92:95], v[124:127], v[76:79]
ds_read_b128 v[124:127], v13 offset:30720
s_waitcnt vmcnt(12) lgkmcnt(1)
s_barrier
v_mfma_f32_16x16x32_bf16 v[16:19], v[96:99], v[112:115], v[16:19]
s_add_u32 m0, s33, 4096
s_mov_b32 s35, 327680
v_mfma_f32_16x16x32_bf16 v[32:35], v[100:103], v[112:115], v[32:35]
buffer_load_dwordx4 v4, s[8:11], s35 offen offset:0 lds
buffer_load_dwordx4 v5, s[8:11], s35 offen offset:1024 lds
v_mfma_f32_16x16x32_bf16 v[48:51], v[104:107], v[112:115], v[48:51]
buffer_load_dwordx4 v6, s[8:11], s35 offen offset:2048 lds
v_mfma_f32_16x16x32_bf16 v[64:67], v[108:111], v[112:115], v[64:67]
buffer_load_dwordx4 v7, s[8:11], s35 offen offset:3072 lds
s_waitcnt lgkmcnt(7)
v_mfma_f32_16x16x32_bf16 v[20:23], v[96:99], v[116:119], v[20:23]
ds_read_b128 v[112:115], v12 offset:32768
v_mfma_f32_16x16x32_bf16 v[36:39], v[100:103], v[116:119], v[36:39]
s_waitcnt vmcnt(8)
ds_read_b64_tr_b16 v[80:81], v8 offset:8192
v_mfma_f32_16x16x32_bf16 v[52:55], v[104:107], v[116:119], v[52:55]
ds_read_b64_tr_b16 v[82:83], v8 offset:8704
v_mfma_f32_16x16x32_bf16 v[68:71], v[108:111], v[116:119], v[68:71]
ds_read_b64_tr_b16 v[84:85], v9 offset:8192
s_waitcnt lgkmcnt(6)
v_mfma_f32_16x16x32_bf16 v[24:27], v[96:99], v[120:123], v[24:27]
ds_read_b128 v[116:119], v12 offset:34816
ds_read_b64_tr_b16 v[86:87], v9 offset:8704
v_mfma_f32_16x16x32_bf16 v[40:43], v[100:103], v[120:123], v[40:43]
ds_read_b64_tr_b16 v[88:89], v10 offset:8192
v_mfma_f32_16x16x32_bf16 v[56:59], v[104:107], v[120:123], v[56:59]
ds_read_b64_tr_b16 v[90:91], v10 offset:8704
v_mfma_f32_16x16x32_bf16 v[72:75], v[108:111], v[120:123], v[72:75]
ds_read_b64_tr_b16 v[92:93], v11 offset:8192
s_waitcnt lgkmcnt(9)
v_mfma_f32_16x16x32_bf16 v[28:31], v[96:99], v[124:127], v[28:31]
ds_read_b128 v[120:123], v12 offset:36864
ds_read_b64_tr_b16 v[94:95], v11 offset:8704
v_mfma_f32_16x16x32_bf16 v[44:47], v[100:103], v[124:127], v[44:47]
v_mfma_f32_16x16x32_bf16 v[60:63], v[104:107], v[124:127], v[60:63]
v_mfma_f32_16x16x32_bf16 v[76:79], v[108:111], v[124:127], v[76:79]
ds_read_b128 v[124:127], v12 offset:38912
s_waitcnt lgkmcnt(1)
v_mfma_f32_16x16x32_bf16 v[16:19], v[80:83], v[112:115], v[16:19]
s_add_u32 m0, s33, 8192
s_mov_b32 s35, 360448
v_mfma_f32_16x16x32_bf16 v[32:35], v[84:87], v[112:115], v[32:35]
buffer_load_dwordx4 v4, s[8:11], s35 offen offset:0 lds
buffer_load_dwordx4 v5, s[8:11], s35 offen offset:1024 lds
v_mfma_f32_16x16x32_bf16 v[48:51], v[88:91], v[112:115], v[48:51]
buffer_load_dwordx4 v6, s[8:11], s35 offen offset:2048 lds
v_mfma_f32_16x16x32_bf16 v[64:67], v[92:95], v[112:115], v[64:67]
buffer_load_dwordx4 v7, s[8:11], s35 offen offset:3072 lds
s_waitcnt lgkmcnt(7)
v_mfma_f32_16x16x32_bf16 v[20:23], v[80:83], v[116:119], v[20:23]
ds_read_b128 v[112:115], v13 offset:32768
v_mfma_f32_16x16x32_bf16 v[36:39], v[84:87], v[116:119], v[36:39]
s_waitcnt vmcnt(8)
ds_read_b64_tr_b16 v[96:97], v8 offset:0
v_mfma_f32_16x16x32_bf16 v[52:55], v[88:91], v[116:119], v[52:55]
ds_read_b64_tr_b16 v[98:99], v8 offset:512
v_mfma_f32_16x16x32_bf16 v[68:71], v[92:95], v[116:119], v[68:71]
ds_read_b64_tr_b16 v[100:101], v9 offset:0
s_waitcnt lgkmcnt(6)
v_mfma_f32_16x16x32_bf16 v[24:27], v[80:83], v[120:123], v[24:27]
ds_read_b128 v[116:119], v13 offset:34816
ds_read_b64_tr_b16 v[102:103], v9 offset:512
v_mfma_f32_16x16x32_bf16 v[40:43], v[84:87], v[120:123], v[40:43]
ds_read_b64_tr_b16 v[104:105], v10 offset:0
v_mfma_f32_16x16x32_bf16 v[56:59], v[88:91], v[120:123], v[56:59]
ds_read_b64_tr_b16 v[106:107], v10 offset:512
v_mfma_f32_16x16x32_bf16 v[72:75], v[92:95], v[120:123], v[72:75]
ds_read_b64_tr_b16 v[108:109], v11 offset:0
s_waitcnt lgkmcnt(9)
v_mfma_f32_16x16x32_bf16 v[28:31], v[80:83], v[124:127], v[28:31]
ds_read_b128 v[120:123], v13 offset:36864
ds_read_b64_tr_b16 v[110:111], v11 offset:512
v_mfma_f32_16x16x32_bf16 v[44:47], v[84:87], v[124:127], v[44:47]
v_mfma_f32_16x16x32_bf16 v[60:63], v[88:91], v[124:127], v[60:63]
v_mfma_f32_16x16x32_bf16 v[76:79], v[92:95], v[124:127], v[76:79]
ds_read_b128 v[124:127], v13 offset:38912
s_waitcnt lgkmcnt(1)
v_mfma_f32_16x16x32_bf16 v[16:19], v[96:99], v[112:115], v[16:19]
s_add_u32 m0, s33, 0
s_mov_b32 s35, 393216
v_mfma_f32_16x16x32_bf16 v[32:35], v[100:103], v[112:115], v[32:35]
buffer_load_dwordx4 v4, s[8:11], s35 offen offset:0 lds
buffer_load_dwordx4 v5, s[8:11], s35 offen offset:1024 lds
v_mfma_f32_16x16x32_bf16 v[48:51], v[104:107], v[112:115], v[48:51]
buffer_load_dwordx4 v6, s[8:11], s35 offen offset:2048 lds
v_mfma_f32_16x16x32_bf16 v[64:67], v[108:111], v[112:115], v[64:67]
buffer_load_dwordx4 v7, s[8:11], s35 offen offset:3072 lds
s_waitcnt lgkmcnt(7)
v_mfma_f32_16x16x32_bf16 v[20:23], v[96:99], v[116:119], v[20:23]
ds_read_b128 v[112:115], v12 offset:40960
v_mfma_f32_16x16x32_bf16 v[36:39], v[100:103], v[116:119], v[36:39]
s_waitcnt vmcnt(8)
ds_read_b64_tr_b16 v[80:81], v8 offset:4096
v_mfma_f32_16x16x32_bf16 v[52:55], v[104:107], v[116:119], v[52:55]
ds_read_b64_tr_b16 v[82:83], v8 offset:4608
v_mfma_f32_16x16x32_bf16 v[68:71], v[108:111], v[116:119], v[68:71]
ds_read_b64_tr_b16 v[84:85], v9 offset:4096
s_waitcnt lgkmcnt(6)
v_mfma_f32_16x16x32_bf16 v[24:27], v[96:99], v[120:123], v[24:27]
ds_read_b128 v[116:119], v12 offset:43008
ds_read_b64_tr_b16 v[86:87], v9 offset:4608
v_mfma_f32_16x16x32_bf16 v[40:43], v[100:103], v[120:123], v[40:43]
ds_read_b64_tr_b16 v[88:89], v10 offset:4096
v_mfma_f32_16x16x32_bf16 v[56:59], v[104:107], v[120:123], v[56:59]
ds_read_b64_tr_b16 v[90:91], v10 offset:4608
v_mfma_f32_16x16x32_bf16 v[72:75], v[108:111], v[120:123], v[72:75]
ds_read_b64_tr_b16 v[92:93], v11 offset:4096
s_waitcnt lgkmcnt(9)
v_mfma_f32_16x16x32_bf16 v[28:31], v[96:99], v[124:127], v[28:31]
ds_read_b128 v[120:123], v12 offset:45056
ds_read_b64_tr_b16 v[94:95], v11 offset:4608
v_mfma_f32_16x16x32_bf16 v[44:47], v[100:103], v[124:127], v[44:47]
v_mfma_f32_16x16x32_bf16 v[60:63], v[104:107], v[124:127], v[60:63]
v_mfma_f32_16x16x32_bf16 v[76:79], v[108:111], v[124:127], v[76:79]
ds_read_b128 v[124:127], v12 offset:47104
s_waitcnt lgkmcnt(1)
v_mfma_f32_16x16x32_bf16 v[16:19], v[80:83], v[112:115], v[16:19]
s_add_u32 m0, s33, 4096
s_mov_b32 s35, 425984
v_mfma_f32_16x16x32_bf16 v[32:35], v[84:87], v[112:115], v[32:35]
buffer_load_dwordx4 v4, s[8:11], s35 offen offset:0 lds
buffer_load_dwordx4 v5, s[8:11], s35 offen offset:1024 lds
v_mfma_f32_16x16x32_bf16 v[48:51], v[88:91], v[112:115], v[48:51]
buffer_load_dwordx4 v6, s[8:11], s35 offen offset:2048 lds
v_mfma_f32_16x16x32_bf16 v[64:67], v[92:95], v[112:115], v[64:67]
buffer_load_dwordx4 v7, s[8:11], s35 offen offset:3072 lds
s_waitcnt lgkmcnt(7)
v_mfma_f32_16x16x32_bf16 v[20:23], v[80:83], v[116:119], v[20:23]
ds_read_b128 v[112:115], v13 offset:40960
v_mfma_f32_16x16x32_bf16 v[36:39], v[84:87], v[116:119], v[36:39]
s_waitcnt vmcnt(8)
ds_read_b64_tr_b16 v[96:97], v8 offset:8192
v_mfma_f32_16x16x32_bf16 v[52:55], v[88:91], v[116:119], v[52:55]
ds_read_b64_tr_b16 v[98:99], v8 offset:8704
v_mfma_f32_16x16x32_bf16 v[68:71], v[92:95], v[116:119], v[68:71]
ds_read_b64_tr_b16 v[100:101], v9 offset:8192
s_waitcnt lgkmcnt(6)
v_mfma_f32_16x16x32_bf16 v[24:27], v[80:83], v[120:123], v[24:27]
ds_read_b128 v[116:119], v13 offset:43008
ds_read_b64_tr_b16 v[102:103], v9 offset:8704
v_mfma_f32_16x16x32_bf16 v[40:43], v[84:87], v[120:123], v[40:43]
ds_read_b64_tr_b16 v[104:105], v10 offset:8192
v_mfma_f32_16x16x32_bf16 v[56:59], v[88:91], v[120:123], v[56:59]
ds_read_b64_tr_b16 v[106:107], v10 offset:8704
v_mfma_f32_16x16x32_bf16 v[72:75], v[92:95], v[120:123], v[72:75]
ds_read_b64_tr_b16 v[108:109], v11 offset:8192
s_waitcnt lgkmcnt(9)
v_mfma_f32_16x16x32_bf16 v[28:31], v[80:83], v[124:127], v[28:31]
ds_read_b128 v[120:123], v13 offset:45056
ds_read_b64_tr_b16 v[110:111], v11 offset:8704
v_mfma_f32_16x16x32_bf16 v[44:47], v[84:87], v[124:127], v[44:47]
v_mfma_f32_16x16x32_bf16 v[60:63], v[88:91], v[124:127], v[60:63]
v_mfma_f32_16x16x32_bf16 v[76:79], v[92:95], v[124:127], v[76:79]
ds_read_b128 v[124:127], v13 offset:47104
s_waitcnt lgkmcnt(1)
v_mfma_f32_16x16x32_bf16 v[16:19], v[96:99], v[112:115], v[16:19]
s_add_u32 m0, s33, 8192
s_add_u32 s37, s31, 0
v_mfma_f32_16x16x32_bf16 v[32:35], v[100:103], v[112:115], v[32:35]
buffer_load_dwordx4 v2, s[12:15], s37 offen lds
s_add_u32 m0, s33, 9216
v_mfma_f32_16x16x32_bf16 v[48:51], v[104:107], v[112:115], v[48:51]
s_add_u32 s37, s31, 0
buffer_load_dwordx4 v3, s[12:15], s37 offen lds
s_add_u32 m0, s33, 10240
v_mfma_f32_16x16x32_bf16 v[64:67], v[108:111], v[112:115], v[64:67]
s_add_u32 s37, s31, 1024
buffer_load_dwordx4 v2, s[12:15], s37 offen lds
s_add_u32 m0, s33, 11264
s_waitcnt lgkmcnt(7)
v_mfma_f32_16x16x32_bf16 v[20:23], v[96:99], v[116:119], v[20:23]
s_add_u32 s37, s31, 1024
buffer_load_dwordx4 v3, s[12:15], s37 offen lds
ds_read_b128 v[112:115], v12 offset:49152
v_mfma_f32_16x16x32_bf16 v[36:39], v[100:103], v[116:119], v[36:39]
s_waitcnt vmcnt(8)
ds_read_b64_tr_b16 v[80:81], v8 offset:0
v_mfma_f32_16x16x32_bf16 v[52:55], v[104:107], v[116:119], v[52:55]
ds_read_b64_tr_b16 v[82:83], v8 offset:512
v_mfma_f32_16x16x32_bf16 v[68:71], v[108:111], v[116:119], v[68:71]
ds_read_b64_tr_b16 v[84:85], v9 offset:0
s_waitcnt lgkmcnt(6)
v_mfma_f32_16x16x32_bf16 v[24:27], v[96:99], v[120:123], v[24:27]
ds_read_b128 v[116:119], v12 offset:51200
ds_read_b64_tr_b16 v[86:87], v9 offset:512
v_mfma_f32_16x16x32_bf16 v[40:43], v[100:103], v[120:123], v[40:43]
ds_read_b64_tr_b16 v[88:89], v10 offset:0
v_mfma_f32_16x16x32_bf16 v[56:59], v[104:107], v[120:123], v[56:59]
ds_read_b64_tr_b16 v[90:91], v10 offset:512
v_mfma_f32_16x16x32_bf16 v[72:75], v[108:111], v[120:123], v[72:75]
ds_read_b64_tr_b16 v[92:93], v11 offset:0
s_waitcnt lgkmcnt(9)
v_mfma_f32_16x16x32_bf16 v[28:31], v[96:99], v[124:127], v[28:31]
ds_read_b128 v[120:123], v12 offset:53248
ds_read_b64_tr_b16 v[94:95], v11 offset:512
v_mfma_f32_16x16x32_bf16 v[44:47], v[100:103], v[124:127], v[44:47]
v_mfma_f32_16x16x32_bf16 v[60:63], v[104:107], v[124:127], v[60:63]
v_mfma_f32_16x16x32_bf16 v[76:79], v[108:111], v[124:127], v[76:79]
ds_read_b128 v[124:127], v12 offset:55296
s_waitcnt lgkmcnt(1)
v_mfma_f32_16x16x32_bf16 v[16:19], v[80:83], v[112:115], v[16:19]
s_add_u32 m0, s33, 0
s_add_u32 s37, s31, 32768
v_mfma_f32_16x16x32_bf16 v[32:35], v[84:87], v[112:115], v[32:35]
buffer_load_dwordx4 v2, s[12:15], s37 offen lds
s_add_u32 m0, s33, 1024
v_mfma_f32_16x16x32_bf16 v[48:51], v[88:91], v[112:115], v[48:51]
s_add_u32 s37, s31, 32768
buffer_load_dwordx4 v3, s[12:15], s37 offen lds
s_add_u32 m0, s33, 2048
v_mfma_f32_16x16x32_bf16 v[64:67], v[92:95], v[112:115], v[64:67]
s_add_u32 s37, s31, 33792
buffer_load_dwordx4 v2, s[12:15], s37 offen lds
s_add_u32 m0, s33, 3072
s_waitcnt lgkmcnt(7)
v_mfma_f32_16x16x32_bf16 v[20:23], v[80:83], v[116:119], v[20:23]
s_add_u32 s37, s31, 33792
buffer_load_dwordx4 v3, s[12:15], s37 offen lds
ds_read_b128 v[112:115], v13 offset:49152
v_mfma_f32_16x16x32_bf16 v[36:39], v[84:87], v[116:119], v[36:39]
s_waitcnt vmcnt(8)
ds_read_b64_tr_b16 v[96:97], v8 offset:4096
v_mfma_f32_16x16x32_bf16 v[52:55], v[88:91], v[116:119], v[52:55]
ds_read_b64_tr_b16 v[98:99], v8 offset:4608
v_mfma_f32_16x16x32_bf16 v[68:71], v[92:95], v[116:119], v[68:71]
ds_read_b64_tr_b16 v[100:101], v9 offset:4096
s_waitcnt lgkmcnt(6)
v_mfma_f32_16x16x32_bf16 v[24:27], v[80:83], v[120:123], v[24:27]
ds_read_b128 v[116:119], v13 offset:51200
ds_read_b64_tr_b16 v[102:103], v9 offset:4608
v_mfma_f32_16x16x32_bf16 v[40:43], v[84:87], v[120:123], v[40:43]
ds_read_b64_tr_b16 v[104:105], v10 offset:4096
v_mfma_f32_16x16x32_bf16 v[56:59], v[88:91], v[120:123], v[56:59]
ds_read_b64_tr_b16 v[106:107], v10 offset:4608
v_mfma_f32_16x16x32_bf16 v[72:75], v[92:95], v[120:123], v[72:75]
ds_read_b64_tr_b16 v[108:109], v11 offset:4096
s_waitcnt lgkmcnt(9)
v_mfma_f32_16x16x32_bf16 v[28:31], v[80:83], v[124:127], v[28:31]
ds_read_b128 v[120:123], v13 offset:53248
ds_read_b64_tr_b16 v[110:111], v11 offset:4608
v_mfma_f32_16x16x32_bf16 v[44:47], v[84:87], v[124:127], v[44:47]
v_mfma_f32_16x16x32_bf16 v[60:63], v[88:91], v[124:127], v[60:63]
v_mfma_f32_16x16x32_bf16 v[76:79], v[92:95], v[124:127], v[76:79]
ds_read_b128 v[124:127], v13 offset:55296
s_waitcnt lgkmcnt(1)
v_mfma_f32_16x16x32_bf16 v[16:19], v[96:99], v[112:115], v[16:19]
s_add_u32 m0, s33, 4096
s_mov_b32 s35, 458752
v_mfma_f32_16x16x32_bf16 v[32:35], v[100:103], v[112:115], v[32:35]
buffer_load_dwordx4 v4, s[8:11], s35 offen offset:0 lds
buffer_load_dwordx4 v5, s[8:11], s35 offen offset:1024 lds
v_mfma_f32_16x16x32_bf16 v[48:51], v[104:107], v[112:115], v[48:51]
buffer_load_dwordx4 v6, s[8:11], s35 offen offset:2048 lds
v_mfma_f32_16x16x32_bf16 v[64:67], v[108:111], v[112:115], v[64:67]
buffer_load_dwordx4 v7, s[8:11], s35 offen offset:3072 lds
s_waitcnt lgkmcnt(7)
v_mfma_f32_16x16x32_bf16 v[20:23], v[96:99], v[116:119], v[20:23]
ds_read_b128 v[112:115], v12 offset:57344
v_mfma_f32_16x16x32_bf16 v[36:39], v[100:103], v[116:119], v[36:39]
s_waitcnt vmcnt(8)
ds_read_b128 v[80:83], v14 offset:8192
v_mfma_f32_16x16x32_bf16 v[52:55], v[104:107], v[116:119], v[52:55]
ds_read_b128 v[84:87], v15 offset:8192
v_mfma_f32_16x16x32_bf16 v[68:71], v[108:111], v[116:119], v[68:71]
ds_read_b128 v[88:91], v14 offset:10240
s_waitcnt lgkmcnt(6)
v_mfma_f32_16x16x32_bf16 v[24:27], v[96:99], v[120:123], v[24:27]
ds_read_b128 v[116:119], v12 offset:59392
ds_read_b128 v[92:95], v15 offset:10240
v_mfma_f32_16x16x32_bf16 v[40:43], v[100:103], v[120:123], v[40:43]
v_mfma_f32_16x16x32_bf16 v[56:59], v[104:107], v[120:123], v[56:59]
v_mfma_f32_16x16x32_bf16 v[72:75], v[108:111], v[120:123], v[72:75]
ds_read_b128 v[120:123], v12 offset:61440
s_waitcnt lgkmcnt(7)
v_mfma_f32_16x16x32_bf16 v[28:31], v[96:99], v[124:127], v[28:31]
v_mfma_f32_16x16x32_bf16 v[44:47], v[100:103], v[124:127], v[44:47]
v_mfma_f32_16x16x32_bf16 v[60:63], v[104:107], v[124:127], v[60:63]
v_mfma_f32_16x16x32_bf16 v[76:79], v[108:111], v[124:127], v[76:79]
ds_read_b128 v[124:127], v12 offset:63488
s_waitcnt lgkmcnt(2)
v_mfma_f32_16x16x32_bf16 v[16:19], v[128:131], v[80:83], v[16:19]
s_add_u32 m0, s33, 8192
s_mov_b32 s35, 491520
v_mfma_f32_16x16x32_bf16 v[32:35], v[132:135], v[80:83], v[32:35]
buffer_load_dwordx4 v4, s[8:11], s35 offen offset:0 lds
buffer_load_dwordx4 v5, s[8:11], s35 offen offset:1024 lds
v_mfma_f32_16x16x32_bf16 v[48:51], v[128:131], v[84:87], v[48:51]
buffer_load_dwordx4 v6, s[8:11], s35 offen offset:2048 lds
buffer_load_dwordx4 v7, s[8:11], s35 offen offset:3072 lds
v_mfma_f32_16x16x32_bf16 v[64:67], v[132:135], v[84:87], v[64:67]
s_waitcnt vmcnt(8)
ds_read_b128 v[96:99], v14 offset:0
v_mfma_f32_16x16x32_bf16 v[20:23], v[128:131], v[88:91], v[20:23]
ds_read_b128 v[100:103], v15 offset:0
ds_read_b128 v[104:107], v14 offset:2048
v_mfma_f32_16x16x32_bf16 v[36:39], v[132:135], v[88:91], v[36:39]
ds_read_b128 v[108:111], v15 offset:2048
v_mfma_f32_16x16x32_bf16 v[52:55], v[128:131], v[92:95], v[52:55]
v_mfma_f32_16x16x32_bf16 v[68:71], v[132:135], v[92:95], v[68:71]
s_waitcnt lgkmcnt(0)
v_mfma_f32_16x16x32_bf16 v[24:27], v[128:131], v[96:99], v[24:27]
v_mfma_f32_16x16x32_bf16 v[40:43], v[132:135], v[96:99], v[40:43]
v_mfma_f32_16x16x32_bf16 v[56:59], v[128:131], v[100:103], v[56:59]
s_waitcnt vmcnt(4)
ds_read_b64_tr_b16 v[80:81], v8 offset:4096
v_mfma_f32_16x16x32_bf16 v[72:75], v[132:135], v[100:103], v[72:75]
ds_read_b64_tr_b16 v[82:83], v8 offset:4608
ds_read_b64_tr_b16 v[84:85], v9 offset:4096
v_mfma_f32_16x16x32_bf16 v[28:31], v[128:131], v[104:107], v[28:31]
ds_read_b64_tr_b16 v[86:87], v9 offset:4608
ds_read_b64_tr_b16 v[88:89], v10 offset:4096
v_mfma_f32_16x16x32_bf16 v[44:47], v[132:135], v[104:107], v[44:47]
ds_read_b64_tr_b16 v[90:91], v10 offset:4608
ds_read_b64_tr_b16 v[92:93], v11 offset:4096
v_mfma_f32_16x16x32_bf16 v[60:63], v[128:131], v[108:111], v[60:63]
ds_read_b64_tr_b16 v[94:95], v11 offset:4608
v_mfma_f32_16x16x32_bf16 v[76:79], v[132:135], v[108:111], v[76:79]
s_waitcnt lgkmcnt(0)
v_mfma_f32_16x16x32_bf16 v[16:19], v[80:83], v[112:115], v[16:19]
v_mfma_f32_16x16x32_bf16 v[32:35], v[84:87], v[112:115], v[32:35]
v_mfma_f32_16x16x32_bf16 v[48:51], v[88:91], v[112:115], v[48:51]
v_mfma_f32_16x16x32_bf16 v[64:67], v[92:95], v[112:115], v[64:67]
ds_read_b128 v[112:115], v13 offset:57344
s_waitcnt lgkmcnt(15)
v_mfma_f32_16x16x32_bf16 v[20:23], v[80:83], v[116:119], v[20:23]
v_mfma_f32_16x16x32_bf16 v[36:39], v[84:87], v[116:119], v[36:39]
s_waitcnt vmcnt(0)
ds_read_b64_tr_b16 v[96:97], v8 offset:8192
v_mfma_f32_16x16x32_bf16 v[52:55], v[88:91], v[116:119], v[52:55]
ds_read_b64_tr_b16 v[98:99], v8 offset:8704
v_mfma_f32_16x16x32_bf16 v[68:71], v[92:95], v[116:119], v[68:71]
ds_read_b64_tr_b16 v[100:101], v9 offset:8192
s_waitcnt lgkmcnt(15)
v_mfma_f32_16x16x32_bf16 v[24:27], v[80:83], v[120:123], v[24:27]
ds_read_b128 v[116:119], v13 offset:59392
ds_read_b64_tr_b16 v[102:103], v9 offset:8704
v_mfma_f32_16x16x32_bf16 v[40:43], v[84:87], v[120:123], v[40:43]
ds_read_b64_tr_b16 v[104:105], v10 offset:8192
v_mfma_f32_16x16x32_bf16 v[56:59], v[88:91], v[120:123], v[56:59]
ds_read_b64_tr_b16 v[106:107], v10 offset:8704
v_mfma_f32_16x16x32_bf16 v[72:75], v[92:95], v[120:123], v[72:75]
ds_read_b64_tr_b16 v[108:109], v11 offset:8192
s_waitcnt lgkmcnt(15)
v_mfma_f32_16x16x32_bf16 v[28:31], v[80:83], v[124:127], v[28:31]
ds_read_b128 v[120:123], v13 offset:61440
ds_read_b64_tr_b16 v[110:111], v11 offset:8704
v_mfma_f32_16x16x32_bf16 v[44:47], v[84:87], v[124:127], v[44:47]
v_mfma_f32_16x16x32_bf16 v[60:63], v[88:91], v[124:127], v[60:63]
v_mfma_f32_16x16x32_bf16 v[76:79], v[92:95], v[124:127], v[76:79]
ds_read_b128 v[124:127], v13 offset:63488
s_waitcnt lgkmcnt(1)
v_mfma_f32_16x16x32_bf16 v[16:19], v[96:99], v[112:115], v[16:19]
v_mfma_f32_16x16x32_bf16 v[32:35], v[100:103], v[112:115], v[32:35]
v_mfma_f32_16x16x32_bf16 v[48:51], v[104:107], v[112:115], v[48:51]
v_mfma_f32_16x16x32_bf16 v[64:67], v[108:111], v[112:115], v[64:67]
s_waitcnt lgkmcnt(7)
v_mfma_f32_16x16x32_bf16 v[20:23], v[96:99], v[116:119], v[20:23]
v_mfma_f32_16x16x32_bf16 v[36:39], v[100:103], v[116:119], v[36:39]
v_mfma_f32_16x16x32_bf16 v[52:55], v[104:107], v[116:119], v[52:55]
v_mfma_f32_16x16x32_bf16 v[68:71], v[108:111], v[116:119], v[68:71]
s_waitcnt lgkmcnt(2)
v_mfma_f32_16x16x32_bf16 v[24:27], v[96:99], v[120:123], v[24:27]
v_mfma_f32_16x16x32_bf16 v[40:43], v[100:103], v[120:123], v[40:43]
v_mfma_f32_16x16x32_bf16 v[56:59], v[104:107], v[120:123], v[56:59]
v_mfma_f32_16x16x32_bf16 v[72:75], v[108:111], v[120:123], v[72:75]
s_waitcnt lgkmcnt(0)
v_mfma_f32_16x16x32_bf16 v[28:31], v[96:99], v[124:127], v[28:31]
v_mfma_f32_16x16x32_bf16 v[44:47], v[100:103], v[124:127], v[44:47]
v_mfma_f32_16x16x32_bf16 v[60:63], v[104:107], v[124:127], v[60:63]
v_mfma_f32_16x16x32_bf16 v[76:79], v[108:111], v[124:127], v[76:79]
s_setprio 0
s_nop 7
v_lshlrev_b32 v4, 4, v1
s_lshr_b32 s36, s28, 3
s_lshl_b32 s36, s36, 19
s_and_b32 s37, s28, 7
s_lshl_b32 s37, s37, 10
s_add_u32 s36, s36, s37
s_and_b32 s37, s24, 3
s_lshl_b32 s37, s37, 14
s_add_u32 s36, s36, s37
s_add_u32 s36, s36, 9437184
s_cmp_ge_u32 s24, 4
s_cbranch_scc1 cn_k1_kernel_eb
s_nop 1
v_cvt_pk_bf16_f32 v140, v16, v17
v_cvt_pk_bf16_f32 v141, v18, v19
v_cvt_pk_bf16_f32 v142, v32, v33
v_cvt_pk_bf16_f32 v143, v34, v35
s_add_u32 s37, s36, 0
buffer_store_dwordx4 v[140:143], v4, s[20:23], s37 offen sc1
v_pk_add_f32 v[96:97], v[16:17], v[18:19]
v_pk_add_f32 v[98:99], v[20:21], v[22:23]
v_pk_add_f32 v[100:101], v[24:25], v[26:27]
v_pk_add_f32 v[102:103], v[28:29], v[30:31]
v_pk_mul_f32 v[104:105], v[16:17], v[16:17]
v_pk_mul_f32 v[106:107], v[20:21], v[20:21]
v_pk_mul_f32 v[108:109], v[24:25], v[24:25]
v_pk_mul_f32 v[110:111], v[28:29], v[28:29]
v_pk_fma_f32 v[104:105], v[18:19], v[18:19], v[104:105]
v_pk_fma_f32 v[106:107], v[22:23], v[22:23], v[106:107]
v_cvt_pk_bf16_f32 v144, -v20, -v21
v_cvt_pk_bf16_f32 v145, -v22, -v23
v_cvt_pk_bf16_f32 v146, -v36, -v37
v_cvt_pk_bf16_f32 v147, -v38, -v39
s_add_u32 s37, s36, 196608
buffer_store_dwordx4 v[144:147], v4, s[20:23], s37 offen sc1
v_pk_fma_f32 v[108:109], v[26:27], v[26:27], v[108:109]
v_pk_fma_f32 v[110:111], v[30:31], v[30:31], v[110:111]
v_pk_add_f32 v[96:97], v[96:97], v[32:33]
v_pk_add_f32 v[98:99], v[98:99], v[36:37]
v_pk_add_f32 v[100:101], v[100:101], v[40:41]
v_pk_add_f32 v[102:103], v[102:103], v[44:45]
v_pk_fma_f32 v[104:105], v[32:33], v[32:33], v[104:105]
v_pk_fma_f32 v[106:107], v[36:37], v[36:37], v[106:107]
v_pk_fma_f32 v[108:109], v[40:41], v[40:41], v[108:109]
v_pk_fma_f32 v[110:111], v[44:45], v[44:45], v[110:111]
v_pk_add_f32 v[96:97], v[96:97], v[34:35]
v_cvt_pk_bf16_f32 v148, v48, v49
v_cvt_pk_bf16_f32 v149, v50, v51
v_cvt_pk_bf16_f32 v150, v64, v65
v_cvt_pk_bf16_f32 v151, v66, v67
s_add_u32 s37, s36, 8192
buffer_store_dwordx4 v[148:151], v4, s[20:23], s37 offen sc1
v_pk_add_f32 v[98:99], v[98:99], v[38:39]
v_pk_add_f32 v[100:101], v[100:101], v[42:43]
v_pk_add_f32 v[102:103], v[102:103], v[46:47]
v_pk_fma_f32 v[104:105], v[34:35], v[34:35], v[104:105]
v_pk_fma_f32 v[106:107], v[38:39], v[38:39], v[106:107]
v_pk_fma_f32 v[108:109], v[42:43], v[42:43], v[108:109]
v_pk_fma_f32 v[110:111], v[46:47], v[46:47], v[110:111]
v_pk_add_f32 v[96:97], v[96:97], v[48:49]
v_pk_add_f32 v[98:99], v[98:99], v[52:53]
v_pk_add_f32 v[100:101], v[100:101], v[56:57]
v_pk_add_f32 v[102:103], v[102:103], v[60:61]
v_cvt_pk_bf16_f32 v152, -v52, -v53
v_cvt_pk_bf16_f32 v153, -v54, -v55
v_cvt_pk_bf16_f32 v154, -v68, -v69
v_cvt_pk_bf16_f32 v155, -v70, -v71
s_add_u32 s37, s36, 204800
buffer_store_dwordx4 v[152:155], v4, s[20:23], s37 offen sc1
v_pk_fma_f32 v[104:105], v[48:49], v[48:49], v[104:105]
v_pk_fma_f32 v[106:107], v[52:53], v[52:53], v[106:107]
v_pk_fma_f32 v[108:109], v[56:57], v[56:57], v[108:109]
v_pk_fma_f32 v[110:111], v[60:61], v[60:61], v[110:111]
v_pk_add_f32 v[96:97], v[96:97], v[50:51]
v_pk_add_f32 v[98:99], v[98:99], v[54:55]
v_pk_add_f32 v[100:101], v[100:101], v[58:59]
v_pk_add_f32 v[102:103], v[102:103], v[62:63]
v_pk_fma_f32 v[104:105], v[50:51], v[50:51], v[104:105]
v_pk_fma_f32 v[106:107], v[54:55], v[54:55], v[106:107]
v_pk_fma_f32 v[108:109], v[58:59], v[58:59], v[108:109]
v_cvt_pk_bf16_f32 v156, v24, v25
v_cvt_pk_bf16_f32 v157, v26, v27
v_cvt_pk_bf16_f32 v158, v40, v41
v_cvt_pk_bf16_f32 v159, v42, v43
s_add_u32 s37, s36, 262144
buffer_store_dwordx4 v[156:159], v4, s[20:23], s37 offen sc1
v_pk_fma_f32 v[110:111], v[62:63], v[62:63], v[110:111]
v_pk_add_f32 v[96:97], v[96:97], v[64:65]
v_pk_add_f32 v[98:99], v[98:99], v[68:69]
v_pk_add_f32 v[100:101], v[100:101], v[72:73]
v_pk_add_f32 v[102:103], v[102:103], v[76:77]
v_pk_fma_f32 v[104:105], v[64:65], v[64:65], v[104:105]
v_pk_fma_f32 v[106:107], v[68:69], v[68:69], v[106:107]
v_pk_fma_f32 v[108:109], v[72:73], v[72:73], v[108:109]
v_pk_fma_f32 v[110:111], v[76:77], v[76:77], v[110:111]
v_pk_add_f32 v[96:97], v[96:97], v[66:67]
v_pk_add_f32 v[98:99], v[98:99], v[70:71]
v_cvt_pk_bf16_f32 v160, -v28, -v29
v_cvt_pk_bf16_f32 v161, -v30, -v31
v_cvt_pk_bf16_f32 v162, -v44, -v45
v_cvt_pk_bf16_f32 v163, -v46, -v47
s_add_u32 s37, s36, 458752
buffer_store_dwordx4 v[160:163], v4, s[20:23], s37 offen sc1
v_pk_add_f32 v[100:101], v[100:101], v[74:75]
v_pk_add_f32 v[102:103], v[102:103], v[78:79]
v_pk_fma_f32 v[104:105], v[66:67], v[66:67], v[104:105]
v_pk_fma_f32 v[106:107], v[70:71], v[70:71], v[106:107]
v_pk_fma_f32 v[108:109], v[74:75], v[74:75], v[108:109]
v_pk_fma_f32 v[110:111], v[78:79], v[78:79], v[110:111]
v_add_f32 v6, v96, v97
v_add_f32 v7, v98, v99
v_add_f32 v8, v100, v101
v_add_f32 v9, v102, v103
v_add_f32 v10, v104, v105
v_cvt_pk_bf16_f32 v164, v56, v57
v_cvt_pk_bf16_f32 v165, v58, v59
v_cvt_pk_bf16_f32 v166, v72, v73
v_cvt_pk_bf16_f32 v167, v74, v75
s_add_u32 s37, s36, 270336
buffer_store_dwordx4 v[164:167], v4, s[20:23], s37 offen sc1
v_add_f32 v11, v106, v107
v_add_f32 v12, v108, v109
v_add_f32 v13, v110, v111
v_mul_f32 v112, 0xbd800000, v6
v_mul_f32 v114, 0xbd800000, v7
v_mul_f32 v116, 0xbd800000, v8
v_mul_f32 v118, 0xbd800000, v9
v_fmac_f32 v10, v112, v6
v_fmac_f32 v11, v114, v7
v_fmac_f32 v12, v116, v8
v_fmac_f32 v13, v118, v9
v_cvt_pk_bf16_f32 v168, -v60, -v61
v_cvt_pk_bf16_f32 v169, -v62, -v63
v_cvt_pk_bf16_f32 v170, -v76, -v77
v_cvt_pk_bf16_f32 v171, -v78, -v79
s_add_u32 s37, s36, 466944
buffer_store_dwordx4 v[168:171], v4, s[20:23], s37 offen sc1
s_branch cn_k1_kernel_ej
cn_k1_kernel_eb:
s_nop 1
v_pk_add_f32 v[124:125], v[16:17], v[20:21]
v_cvt_pk_bf16_f32 v140, v124, v125
v_pk_add_f32 v[124:125], v[18:19], v[22:23]
v_cvt_pk_bf16_f32 v141, v124, v125
v_pk_add_f32 v[124:125], v[32:33], v[36:37]
v_cvt_pk_bf16_f32 v142, v124, v125
v_pk_add_f32 v[124:125], v[34:35], v[38:39]
v_cvt_pk_bf16_f32 v143, v124, v125
s_add_u32 s37, s36, 65536
buffer_store_dwordx4 v[140:143], v4, s[20:23], s37 offen sc1
v_pk_add_f32 v[96:97], v[16:17], v[18:19]
v_pk_add_f32 v[98:99], v[20:21], v[22:23]
v_pk_add_f32 v[100:101], v[24:25], v[26:27]
v_pk_add_f32 v[102:103], v[28:29], v[30:31]
v_pk_mul_f32 v[104:105], v[16:17], v[16:17]
v_pk_mul_f32 v[106:107], v[20:21], v[20:21]
v_pk_mul_f32 v[108:109], v[24:25], v[24:25]
v_pk_mul_f32 v[110:111], v[28:29], v[28:29]
v_pk_fma_f32 v[104:105], v[18:19], v[18:19], v[104:105]
v_pk_fma_f32 v[106:107], v[22:23], v[22:23], v[106:107]
v_pk_add_f32 v[124:125], v[16:17], v[20:21] neg_lo:[0,1] neg_hi:[0,1]
v_cvt_pk_bf16_f32 v144, v124, v125
v_pk_add_f32 v[124:125], v[18:19], v[22:23] neg_lo:[0,1] neg_hi:[0,1]
v_cvt_pk_bf16_f32 v145, v124, v125
v_pk_add_f32 v[124:125], v[32:33], v[36:37] neg_lo:[0,1] neg_hi:[0,1]
v_cvt_pk_bf16_f32 v146, v124, v125
v_pk_add_f32 v[124:125], v[34:35], v[38:39] neg_lo:[0,1] neg_hi:[0,1]
v_cvt_pk_bf16_f32 v147, v124, v125
s_add_u32 s37, s36, 131072
buffer_store_dwordx4 v[144:147], v4, s[20:23], s37 offen sc1
v_pk_fma_f32 v[108:109], v[26:27], v[26:27], v[108:109]
v_pk_fma_f32 v[110:111], v[30:31], v[30:31], v[110:111]
v_pk_add_f32 v[96:97], v[96:97], v[32:33]
v_pk_add_f32 v[98:99], v[98:99], v[36:37]
v_pk_add_f32 v[100:101], v[100:101], v[40:41]
v_pk_add_f32 v[102:103], v[102:103], v[44:45]
v_pk_fma_f32 v[104:105], v[32:33], v[32:33], v[104:105]
v_pk_fma_f32 v[106:107], v[36:37], v[36:37], v[106:107]
v_pk_fma_f32 v[108:109], v[40:41], v[40:41], v[108:109]
v_pk_fma_f32 v[110:111], v[44:45], v[44:45], v[110:111]
v_pk_add_f32 v[96:97], v[96:97], v[34:35]
v_pk_add_f32 v[124:125], v[48:49], v[52:53]
v_cvt_pk_bf16_f32 v148, v124, v125
v_pk_add_f32 v[124:125], v[50:51], v[54:55]
v_cvt_pk_bf16_f32 v149, v124, v125
v_pk_add_f32 v[124:125], v[64:65], v[68:69]
v_cvt_pk_bf16_f32 v150, v124, v125
v_pk_add_f32 v[124:125], v[66:67], v[70:71]
v_cvt_pk_bf16_f32 v151, v124, v125
s_add_u32 s37, s36, 73728
buffer_store_dwordx4 v[148:151], v4, s[20:23], s37 offen sc1
v_pk_add_f32 v[98:99], v[98:99], v[38:39]
v_pk_add_f32 v[100:101], v[100:101], v[42:43]
v_pk_add_f32 v[102:103], v[102:103], v[46:47]
v_pk_fma_f32 v[104:105], v[34:35], v[34:35], v[104:105]
v_pk_fma_f32 v[106:107], v[38:39], v[38:39], v[106:107]
v_pk_fma_f32 v[108:109], v[42:43], v[42:43], v[108:109]
v_pk_fma_f32 v[110:111], v[46:47], v[46:47], v[110:111]
v_pk_add_f32 v[96:97], v[96:97], v[48:49]
v_pk_add_f32 v[98:99], v[98:99], v[52:53]
v_pk_add_f32 v[100:101], v[100:101], v[56:57]
v_pk_add_f32 v[102:103], v[102:103], v[60:61]
v_pk_add_f32 v[124:125], v[48:49], v[52:53] neg_lo:[0,1] neg_hi:[0,1]
v_cvt_pk_bf16_f32 v152, v124, v125
v_pk_add_f32 v[124:125], v[50:51], v[54:55] neg_lo:[0,1] neg_hi:[0,1]
v_cvt_pk_bf16_f32 v153, v124, v125
v_pk_add_f32 v[124:125], v[64:65], v[68:69] neg_lo:[0,1] neg_hi:[0,1]
v_cvt_pk_bf16_f32 v154, v124, v125
v_pk_add_f32 v[124:125], v[66:67], v[70:71] neg_lo:[0,1] neg_hi:[0,1]
v_cvt_pk_bf16_f32 v155, v124, v125
s_add_u32 s37, s36, 139264
buffer_store_dwordx4 v[152:155], v4, s[20:23], s37 offen sc1
v_pk_fma_f32 v[104:105], v[48:49], v[48:49], v[104:105]
v_pk_fma_f32 v[106:107], v[52:53], v[52:53], v[106:107]
v_pk_fma_f32 v[108:109], v[56:57], v[56:57], v[108:109]
v_pk_fma_f32 v[110:111], v[60:61], v[60:61], v[110:111]
v_pk_add_f32 v[96:97], v[96:97], v[50:51]
v_pk_add_f32 v[98:99], v[98:99], v[54:55]
v_pk_add_f32 v[100:101], v[100:101], v[58:59]
v_pk_add_f32 v[102:103], v[102:103], v[62:63]
v_pk_fma_f32 v[104:105], v[50:51], v[50:51], v[104:105]
v_pk_fma_f32 v[106:107], v[54:55], v[54:55], v[106:107]
v_pk_fma_f32 v[108:109], v[58:59], v[58:59], v[108:109]
v_pk_add_f32 v[124:125], v[24:25], v[28:29]
v_cvt_pk_bf16_f32 v156, v124, v125
v_pk_add_f32 v[124:125], v[26:27], v[30:31]
v_cvt_pk_bf16_f32 v157, v124, v125
v_pk_add_f32 v[124:125], v[40:41], v[44:45]
v_cvt_pk_bf16_f32 v158, v124, v125
v_pk_add_f32 v[124:125], v[42:43], v[46:47]
v_cvt_pk_bf16_f32 v159, v124, v125
s_add_u32 s37, s36, 327680
buffer_store_dwordx4 v[156:159], v4, s[20:23], s37 offen sc1
v_pk_fma_f32 v[110:111], v[62:63], v[62:63], v[110:111]
v_pk_add_f32 v[96:97], v[96:97], v[64:65]
v_pk_add_f32 v[98:99], v[98:99], v[68:69]
v_pk_add_f32 v[100:101], v[100:101], v[72:73]
v_pk_add_f32 v[102:103], v[102:103], v[76:77]
v_pk_fma_f32 v[104:105], v[64:65], v[64:65], v[104:105]
v_pk_fma_f32 v[106:107], v[68:69], v[68:69], v[106:107]
v_pk_fma_f32 v[108:109], v[72:73], v[72:73], v[108:109]
v_pk_fma_f32 v[110:111], v[76:77], v[76:77], v[110:111]
v_pk_add_f32 v[96:97], v[96:97], v[66:67]
v_pk_add_f32 v[98:99], v[98:99], v[70:71]
v_pk_add_f32 v[124:125], v[24:25], v[28:29] neg_lo:[0,1] neg_hi:[0,1]
v_cvt_pk_bf16_f32 v160, v124, v125
v_pk_add_f32 v[124:125], v[26:27], v[30:31] neg_lo:[0,1] neg_hi:[0,1]
v_cvt_pk_bf16_f32 v161, v124, v125
v_pk_add_f32 v[124:125], v[40:41], v[44:45] neg_lo:[0,1] neg_hi:[0,1]
v_cvt_pk_bf16_f32 v162, v124, v125
v_pk_add_f32 v[124:125], v[42:43], v[46:47] neg_lo:[0,1] neg_hi:[0,1]
v_cvt_pk_bf16_f32 v163, v124, v125
s_add_u32 s37, s36, 393216
buffer_store_dwordx4 v[160:163], v4, s[20:23], s37 offen sc1
v_pk_add_f32 v[100:101], v[100:101], v[74:75]
v_pk_add_f32 v[102:103], v[102:103], v[78:79]
v_pk_fma_f32 v[104:105], v[66:67], v[66:67], v[104:105]
v_pk_fma_f32 v[106:107], v[70:71], v[70:71], v[106:107]
v_pk_fma_f32 v[108:109], v[74:75], v[74:75], v[108:109]
v_pk_fma_f32 v[110:111], v[78:79], v[78:79], v[110:111]
v_add_f32 v6, v96, v97
v_add_f32 v7, v98, v99
v_add_f32 v8, v100, v101
v_add_f32 v9, v102, v103
v_add_f32 v10, v104, v105
v_pk_add_f32 v[124:125], v[56:57], v[60:61]
v_cvt_pk_bf16_f32 v164, v124, v125
v_pk_add_f32 v[124:125], v[58:59], v[62:63]
v_cvt_pk_bf16_f32 v165, v124, v125
v_pk_add_f32 v[124:125], v[72:73], v[76:77]
v_cvt_pk_bf16_f32 v166, v124, v125
v_pk_add_f32 v[124:125], v[74:75], v[78:79]
v_cvt_pk_bf16_f32 v167, v124, v125
s_add_u32 s37, s36, 335872
buffer_store_dwordx4 v[164:167], v4, s[20:23], s37 offen sc1
v_add_f32 v11, v106, v107
v_add_f32 v12, v108, v109
v_add_f32 v13, v110, v111
v_mul_f32 v112, 0xbd800000, v6
v_mul_f32 v114, 0xbd800000, v7
v_mul_f32 v116, 0xbd800000, v8
v_mul_f32 v118, 0xbd800000, v9
v_fmac_f32 v10, v112, v6
v_fmac_f32 v11, v114, v7
v_fmac_f32 v12, v116, v8
v_fmac_f32 v13, v118, v9
v_pk_add_f32 v[124:125], v[56:57], v[60:61] neg_lo:[0,1] neg_hi:[0,1]
v_cvt_pk_bf16_f32 v168, v124, v125
v_pk_add_f32 v[124:125], v[58:59], v[62:63] neg_lo:[0,1] neg_hi:[0,1]
v_cvt_pk_bf16_f32 v169, v124, v125
v_pk_add_f32 v[124:125], v[72:73], v[76:77] neg_lo:[0,1] neg_hi:[0,1]
v_cvt_pk_bf16_f32 v170, v124, v125
v_pk_add_f32 v[124:125], v[74:75], v[78:79] neg_lo:[0,1] neg_hi:[0,1]
v_cvt_pk_bf16_f32 v171, v124, v125
s_add_u32 s37, s36, 401408
buffer_store_dwordx4 v[168:171], v4, s[20:23], s37 offen sc1
cn_k1_kernel_ej:
s_nop 1
v_permlane32_swap_b32 v6, v8
v_permlane32_swap_b32 v10, v12
s_nop 0
v_sub_f32 v120, v6, v8
v_add_f32 v6, v6, v8
v_mul_f32 v121, 0x3d000000, v120
v_add_f32 v10, v10, v12
v_fmac_f32 v10, v120, v121
s_nop 1
v_permlane32_swap_b32 v7, v9
v_permlane32_swap_b32 v11, v13
s_nop 0
v_sub_f32 v120, v7, v9
v_add_f32 v7, v7, v9
v_mul_f32 v121, 0x3d000000, v120
v_add_f32 v11, v11, v13
v_fmac_f32 v11, v120, v121
s_nop 1
v_permlane16_swap_b32 v6, v7
v_permlane16_swap_b32 v10, v11
s_nop 0
v_sub_f32 v120, v6, v7
v_add_f32 v6, v6, v7
v_mul_f32 v121, 0x3c800000, v120
v_add_f32 v10, v10, v11
v_fmac_f32 v10, v120, v121
v_mov_b32 v7, v10
v_lshlrev_b32 v8, 3, v1
v_add_u32 v9, s33, v8
ds_write_b64 v9, v[6:7]
v_add_u32 v8, 65536, v8
v_add_u32 v14, 49152, v8
s_waitcnt lgkmcnt(0)
s_barrier
ds_read_b64 v[80:81], v8 offset:0
ds_read_b64 v[82:83], v8 offset:12288
ds_read_b64 v[84:85], v8 offset:24576
ds_read_b64 v[86:87], v8 offset:36864
ds_read_b64 v[88:89], v14 offset:0
ds_read_b64 v[90:91], v14 offset:12288
ds_read_b64 v[92:93], v14 offset:24576
ds_read_b64 v[94:95], v14 offset:36864
v_and_b32 v6, 15, v1
v_lshrrev_b32 v7, 4, v1
v_lshrrev_b32 v9, 1, v6
v_and_b32 v9, 2, v9
v_xor_b32 v9, v9, v7
v_lshlrev_b32 v5, 6, v6
v_lshl_add_u32 v5, v9, 4, v5
s_lshl_b32 s36, s28, 12
s_lshl_b32 s37, s24, 20
s_add_u32 s36, s36, s37
s_add_u32 s36, s36, 1048576
s_waitcnt lgkmcnt(0)
v_pk_add_f32 v[96:97], v[80:81], v[82:83]
v_pk_add_f32 v[98:99], v[84:85], v[86:87]
v_pk_add_f32 v[100:101], v[88:89], v[90:91]
v_pk_add_f32 v[102:103], v[92:93], v[94:95]
v_pk_add_f32 v[96:97], v[96:97], v[98:99]
v_pk_add_f32 v[100:101], v[100:101], v[102:103]
v_pk_add_f32 v[6:7], v[96:97], v[100:101]
v_mul_f32 v8, 0x3e000000, v6
v_sub_f32 v96, v80, v8
v_sub_f32 v97, v82, v8
v_sub_f32 v98, v84, v8
v_sub_f32 v99, v86, v8
v_sub_f32 v100, v88, v8
v_sub_f32 v101, v90, v8
v_sub_f32 v102, v92, v8
v_sub_f32 v103, v94, v8
v_pk_mul_f32 v[10:11], v[96:97], v[96:97]
v_pk_mul_f32 v[12:13], v[98:99], v[98:99]
v_pk_fma_f32 v[10:11], v[100:101], v[100:101], v[10:11]
v_pk_fma_f32 v[12:13], v[102:103], v[102:103], v[12:13]
v_pk_add_f32 v[10:11], v[10:11], v[12:13]
v_add_f32 v9, v10, v11
v_fmac_f32 v7, 0x3c800000, v9
v_mov_b32 v10, 0x3727c5ac
v_fmac_f32 v10, 0x3b000000, v7
v_rsq_f32 v10, v10
v_mul_f32 v6, 0x3b000000, v6
v_mov_b32 v8, v6
v_mov_b32 v12, v10
s_nop 0
v_permlane32_swap_b32 v6, v8
v_permlane32_swap_b32 v10, v12
v_mov_b32 v7, v6
v_mov_b32 v9, v8
v_mov_b32 v11, v10
v_mov_b32 v13, v12
v_permlane16_swap_b32 v6, v7
v_permlane16_swap_b32 v8, v9
v_permlane16_swap_b32 v10, v11
v_permlane16_swap_b32 v12, v13
v_mul_f32 v80, 0xbfb8aa3b, v10
v_mul_f32 v82, 0xbfb8aa3b, v11
v_mul_f32 v84, 0xbfb8aa3b, v12
v_mul_f32 v86, 0xbfb8aa3b, v13
v_mul_f32 v81, -v6, v80
v_mul_f32 v83, -v7, v82
v_mul_f32 v85, -v8, v84
v_mul_f32 v87, -v9, v86
s_mov_b32 s60, 0x00040004
v_pk_fma_f32 v[16:17], v[16:17], v[80:81], v[80:81] op_sel:[0,0,1] op_sel_hi:[1,0,1]
v_exp_f32 v6, v16
v_exp_f32 v7, v17
v_pk_fma_f32 v[18:19], v[18:19], v[80:81], v[80:81] op_sel:[0,0,1] op_sel_hi:[1,0,1]
v_exp_f32 v8, v18
v_exp_f32 v9, v19
v_pk_fma_f32 v[32:33], v[32:33], v[80:81], v[80:81] op_sel:[0,0,1] op_sel_hi:[1,0,1]
v_exp_f32 v10, v32
v_exp_f32 v11, v33
v_pk_fma_f32 v[34:35], v[34:35], v[80:81], v[80:81] op_sel:[0,0,1] op_sel_hi:[1,0,1]
v_exp_f32 v12, v34
v_exp_f32 v13, v35
v_pk_add_f32 v[6:7], v[6:7], 1.0 op_sel_hi:[1,0]
v_rcp_f32 v6, v6
v_rcp_f32 v7, v7
v_pk_add_f32 v[8:9], v[8:9], 1.0 op_sel_hi:[1,0]
v_rcp_f32 v8, v8
v_rcp_f32 v9, v9
v_pk_add_f32 v[10:11], v[10:11], 1.0 op_sel_hi:[1,0]
v_rcp_f32 v10, v10
v_rcp_f32 v11, v11
v_pk_add_f32 v[12:13], v[12:13], 1.0 op_sel_hi:[1,0]
v_rcp_f32 v12, v12
v_rcp_f32 v13, v13
v_pk_mul_f32 v[6:7], v[6:7], v[16:17]
v_cvt_pk_f16_f32 v96, v6, v7
v_pk_add_u16 v96, v96, s60
v_and_b32 v96, 0xfff8fff8, v96
v_pk_mul_f32 v[8:9], v[8:9], v[18:19]
v_cvt_pk_f16_f32 v97, v8, v9
v_pk_add_u16 v97, v97, s60
v_and_b32 v97, 0xfff8fff8, v97
v_pk_mul_f32 v[10:11], v[10:11], v[32:33]
v_cvt_pk_f16_f32 v98, v10, v11
v_pk_add_u16 v98, v98, s60
v_and_b32 v98, 0xfff8fff8, v98
v_pk_mul_f32 v[12:13], v[12:13], v[34:35]
v_cvt_pk_f16_f32 v99, v12, v13
v_pk_add_u16 v99, v99, s60
v_and_b32 v99, 0xfff8fff8, v99
s_add_u32 s37, s36, 0
buffer_store_dwordx4 v[96:99], v5, s[20:23], s37 offen sc1
v_pk_fma_f32 v[48:49], v[48:49], v[80:81], v[80:81] op_sel:[0,0,1] op_sel_hi:[1,0,1]
v_exp_f32 v6, v48
v_exp_f32 v7, v49
v_pk_fma_f32 v[50:51], v[50:51], v[80:81], v[80:81] op_sel:[0,0,1] op_sel_hi:[1,0,1]
v_exp_f32 v8, v50
v_exp_f32 v9, v51
v_pk_fma_f32 v[64:65], v[64:65], v[80:81], v[80:81] op_sel:[0,0,1] op_sel_hi:[1,0,1]
v_exp_f32 v10, v64
v_exp_f32 v11, v65
v_pk_fma_f32 v[66:67], v[66:67], v[80:81], v[80:81] op_sel:[0,0,1] op_sel_hi:[1,0,1]
v_exp_f32 v12, v66
v_exp_f32 v13, v67
v_pk_add_f32 v[6:7], v[6:7], 1.0 op_sel_hi:[1,0]
v_rcp_f32 v6, v6
v_rcp_f32 v7, v7
v_pk_add_f32 v[8:9], v[8:9], 1.0 op_sel_hi:[1,0]
v_rcp_f32 v8, v8
v_rcp_f32 v9, v9
v_pk_add_f32 v[10:11], v[10:11], 1.0 op_sel_hi:[1,0]
v_rcp_f32 v10, v10
v_rcp_f32 v11, v11
v_pk_add_f32 v[12:13], v[12:13], 1.0 op_sel_hi:[1,0]
v_rcp_f32 v12, v12
v_rcp_f32 v13, v13
v_pk_mul_f32 v[6:7], v[6:7], v[48:49]
v_cvt_pk_f16_f32 v100, v6, v7
v_pk_add_u16 v100, v100, s60
v_and_b32 v100, 0xfff8fff8, v100
v_pk_mul_f32 v[8:9], v[8:9], v[50:51]
v_cvt_pk_f16_f32 v101, v8, v9
v_pk_add_u16 v101, v101, s60
v_and_b32 v101, 0xfff8fff8, v101
v_pk_mul_f32 v[10:11], v[10:11], v[64:65]
v_cvt_pk_f16_f32 v102, v10, v11
v_pk_add_u16 v102, v102, s60
v_and_b32 v102, 0xfff8fff8, v102
v_pk_mul_f32 v[12:13], v[12:13], v[66:67]
v_cvt_pk_f16_f32 v103, v12, v13
v_pk_add_u16 v103, v103, s60
v_and_b32 v103, 0xfff8fff8, v103
s_add_u32 s37, s36, 524288
buffer_store_dwordx4 v[100:103], v5, s[20:23], s37 offen sc1
v_pk_fma_f32 v[20:21], v[20:21], v[82:83], v[82:83] op_sel:[0,0,1] op_sel_hi:[1,0,1]
v_exp_f32 v6, v20
v_exp_f32 v7, v21
v_pk_fma_f32 v[22:23], v[22:23], v[82:83], v[82:83] op_sel:[0,0,1] op_sel_hi:[1,0,1]
v_exp_f32 v8, v22
v_exp_f32 v9, v23
v_pk_fma_f32 v[36:37], v[36:37], v[82:83], v[82:83] op_sel:[0,0,1] op_sel_hi:[1,0,1]
v_exp_f32 v10, v36
v_exp_f32 v11, v37
v_pk_fma_f32 v[38:39], v[38:39], v[82:83], v[82:83] op_sel:[0,0,1] op_sel_hi:[1,0,1]
v_exp_f32 v12, v38
v_exp_f32 v13, v39
v_pk_add_f32 v[6:7], v[6:7], 1.0 op_sel_hi:[1,0]
v_rcp_f32 v6, v6
v_rcp_f32 v7, v7
v_pk_add_f32 v[8:9], v[8:9], 1.0 op_sel_hi:[1,0]
v_rcp_f32 v8, v8
v_rcp_f32 v9, v9
v_pk_add_f32 v[10:11], v[10:11], 1.0 op_sel_hi:[1,0]
v_rcp_f32 v10, v10
v_rcp_f32 v11, v11
v_pk_add_f32 v[12:13], v[12:13], 1.0 op_sel_hi:[1,0]
v_rcp_f32 v12, v12
v_rcp_f32 v13, v13
v_pk_mul_f32 v[6:7], v[6:7], v[20:21]
v_cvt_pk_f16_f32 v104, v6, v7
v_pk_add_u16 v104, v104, s60
v_and_b32 v104, 0xfff8fff8, v104
v_pk_mul_f32 v[8:9], v[8:9], v[22:23]
v_cvt_pk_f16_f32 v105, v8, v9
v_pk_add_u16 v105, v105, s60
v_and_b32 v105, 0xfff8fff8, v105
v_pk_mul_f32 v[10:11], v[10:11], v[36:37]
v_cvt_pk_f16_f32 v106, v10, v11
v_pk_add_u16 v106, v106, s60
v_and_b32 v106, 0xfff8fff8, v106
v_pk_mul_f32 v[12:13], v[12:13], v[38:39]
v_cvt_pk_f16_f32 v107, v12, v13
v_pk_add_u16 v107, v107, s60
v_and_b32 v107, 0xfff8fff8, v107
s_add_u32 s37, s36, 2048
buffer_store_dwordx4 v[104:107], v5, s[20:23], s37 offen sc1
v_pk_fma_f32 v[52:53], v[52:53], v[82:83], v[82:83] op_sel:[0,0,1] op_sel_hi:[1,0,1]
v_exp_f32 v6, v52
v_exp_f32 v7, v53
v_pk_fma_f32 v[54:55], v[54:55], v[82:83], v[82:83] op_sel:[0,0,1] op_sel_hi:[1,0,1]
v_exp_f32 v8, v54
v_exp_f32 v9, v55
v_pk_fma_f32 v[68:69], v[68:69], v[82:83], v[82:83] op_sel:[0,0,1] op_sel_hi:[1,0,1]
v_exp_f32 v10, v68
v_exp_f32 v11, v69
v_pk_fma_f32 v[70:71], v[70:71], v[82:83], v[82:83] op_sel:[0,0,1] op_sel_hi:[1,0,1]
v_exp_f32 v12, v70
v_exp_f32 v13, v71
v_pk_add_f32 v[6:7], v[6:7], 1.0 op_sel_hi:[1,0]
v_rcp_f32 v6, v6
v_rcp_f32 v7, v7
v_pk_add_f32 v[8:9], v[8:9], 1.0 op_sel_hi:[1,0]
v_rcp_f32 v8, v8
v_rcp_f32 v9, v9
v_pk_add_f32 v[10:11], v[10:11], 1.0 op_sel_hi:[1,0]
v_rcp_f32 v10, v10
v_rcp_f32 v11, v11
v_pk_add_f32 v[12:13], v[12:13], 1.0 op_sel_hi:[1,0]
v_rcp_f32 v12, v12
v_rcp_f32 v13, v13
v_pk_mul_f32 v[6:7], v[6:7], v[52:53]
v_cvt_pk_f16_f32 v108, v6, v7
v_pk_add_u16 v108, v108, s60
v_and_b32 v108, 0xfff8fff8, v108
v_pk_mul_f32 v[8:9], v[8:9], v[54:55]
v_cvt_pk_f16_f32 v109, v8, v9
v_pk_add_u16 v109, v109, s60
v_and_b32 v109, 0xfff8fff8, v109
v_pk_mul_f32 v[10:11], v[10:11], v[68:69]
v_cvt_pk_f16_f32 v110, v10, v11
v_pk_add_u16 v110, v110, s60
v_and_b32 v110, 0xfff8fff8, v110
v_pk_mul_f32 v[12:13], v[12:13], v[70:71]
v_cvt_pk_f16_f32 v111, v12, v13
v_pk_add_u16 v111, v111, s60
v_and_b32 v111, 0xfff8fff8, v111
s_add_u32 s37, s36, 526336
buffer_store_dwordx4 v[108:111], v5, s[20:23], s37 offen sc1
v_pk_fma_f32 v[24:25], v[24:25], v[84:85], v[84:85] op_sel:[0,0,1] op_sel_hi:[1,0,1]
v_exp_f32 v6, v24
v_exp_f32 v7, v25
v_pk_fma_f32 v[26:27], v[26:27], v[84:85], v[84:85] op_sel:[0,0,1] op_sel_hi:[1,0,1]
v_exp_f32 v8, v26
v_exp_f32 v9, v27
v_pk_fma_f32 v[40:41], v[40:41], v[84:85], v[84:85] op_sel:[0,0,1] op_sel_hi:[1,0,1]
v_exp_f32 v10, v40
v_exp_f32 v11, v41
v_pk_fma_f32 v[42:43], v[42:43], v[84:85], v[84:85] op_sel:[0,0,1] op_sel_hi:[1,0,1]
v_exp_f32 v12, v42
v_exp_f32 v13, v43
v_pk_add_f32 v[6:7], v[6:7], 1.0 op_sel_hi:[1,0]
v_rcp_f32 v6, v6
v_rcp_f32 v7, v7
v_pk_add_f32 v[8:9], v[8:9], 1.0 op_sel_hi:[1,0]
v_rcp_f32 v8, v8
v_rcp_f32 v9, v9
v_pk_add_f32 v[10:11], v[10:11], 1.0 op_sel_hi:[1,0]
v_rcp_f32 v10, v10
v_rcp_f32 v11, v11
v_pk_add_f32 v[12:13], v[12:13], 1.0 op_sel_hi:[1,0]
v_rcp_f32 v12, v12
v_rcp_f32 v13, v13
v_pk_mul_f32 v[6:7], v[6:7], v[24:25]
v_cvt_pk_f16_f32 v96, v6, v7
v_pk_add_u16 v96, v96, s60
v_and_b32 v96, 0xfff8fff8, v96
v_pk_mul_f32 v[8:9], v[8:9], v[26:27]
v_cvt_pk_f16_f32 v97, v8, v9
v_pk_add_u16 v97, v97, s60
v_and_b32 v97, 0xfff8fff8, v97
v_pk_mul_f32 v[10:11], v[10:11], v[40:41]
v_cvt_pk_f16_f32 v98, v10, v11
v_pk_add_u16 v98, v98, s60
v_and_b32 v98, 0xfff8fff8, v98
v_pk_mul_f32 v[12:13], v[12:13], v[42:43]
v_cvt_pk_f16_f32 v99, v12, v13
v_pk_add_u16 v99, v99, s60
v_and_b32 v99, 0xfff8fff8, v99
s_add_u32 s37, s36, 1024
buffer_store_dwordx4 v[96:99], v5, s[20:23], s37 offen sc1
v_pk_fma_f32 v[56:57], v[56:57], v[84:85], v[84:85] op_sel:[0,0,1] op_sel_hi:[1,0,1]
v_exp_f32 v6, v56
v_exp_f32 v7, v57
v_pk_fma_f32 v[58:59], v[58:59], v[84:85], v[84:85] op_sel:[0,0,1] op_sel_hi:[1,0,1]
v_exp_f32 v8, v58
v_exp_f32 v9, v59
v_pk_fma_f32 v[72:73], v[72:73], v[84:85], v[84:85] op_sel:[0,0,1] op_sel_hi:[1,0,1]
v_exp_f32 v10, v72
v_exp_f32 v11, v73
v_pk_fma_f32 v[74:75], v[74:75], v[84:85], v[84:85] op_sel:[0,0,1] op_sel_hi:[1,0,1]
v_exp_f32 v12, v74
v_exp_f32 v13, v75
v_pk_add_f32 v[6:7], v[6:7], 1.0 op_sel_hi:[1,0]
v_rcp_f32 v6, v6
v_rcp_f32 v7, v7
v_pk_add_f32 v[8:9], v[8:9], 1.0 op_sel_hi:[1,0]
v_rcp_f32 v8, v8
v_rcp_f32 v9, v9
v_pk_add_f32 v[10:11], v[10:11], 1.0 op_sel_hi:[1,0]
v_rcp_f32 v10, v10
v_rcp_f32 v11, v11
v_pk_add_f32 v[12:13], v[12:13], 1.0 op_sel_hi:[1,0]
v_rcp_f32 v12, v12
v_rcp_f32 v13, v13
v_pk_mul_f32 v[6:7], v[6:7], v[56:57]
v_cvt_pk_f16_f32 v100, v6, v7
v_pk_add_u16 v100, v100, s60
v_and_b32 v100, 0xfff8fff8, v100
v_pk_mul_f32 v[8:9], v[8:9], v[58:59]
v_cvt_pk_f16_f32 v101, v8, v9
v_pk_add_u16 v101, v101, s60
v_and_b32 v101, 0xfff8fff8, v101
v_pk_mul_f32 v[10:11], v[10:11], v[72:73]
v_cvt_pk_f16_f32 v102, v10, v11
v_pk_add_u16 v102, v102, s60
v_and_b32 v102, 0xfff8fff8, v102
v_pk_mul_f32 v[12:13], v[12:13], v[74:75]
v_cvt_pk_f16_f32 v103, v12, v13
v_pk_add_u16 v103, v103, s60
v_and_b32 v103, 0xfff8fff8, v103
s_add_u32 s37, s36, 525312
buffer_store_dwordx4 v[100:103], v5, s[20:23], s37 offen sc1
v_pk_fma_f32 v[28:29], v[28:29], v[86:87], v[86:87] op_sel:[0,0,1] op_sel_hi:[1,0,1]
v_exp_f32 v6, v28
v_exp_f32 v7, v29
v_pk_fma_f32 v[30:31], v[30:31], v[86:87], v[86:87] op_sel:[0,0,1] op_sel_hi:[1,0,1]
v_exp_f32 v8, v30
v_exp_f32 v9, v31
v_pk_fma_f32 v[44:45], v[44:45], v[86:87], v[86:87] op_sel:[0,0,1] op_sel_hi:[1,0,1]
v_exp_f32 v10, v44
v_exp_f32 v11, v45
v_pk_fma_f32 v[46:47], v[46:47], v[86:87], v[86:87] op_sel:[0,0,1] op_sel_hi:[1,0,1]
v_exp_f32 v12, v46
v_exp_f32 v13, v47
v_pk_add_f32 v[6:7], v[6:7], 1.0 op_sel_hi:[1,0]
v_rcp_f32 v6, v6
v_rcp_f32 v7, v7
v_pk_add_f32 v[8:9], v[8:9], 1.0 op_sel_hi:[1,0]
v_rcp_f32 v8, v8
v_rcp_f32 v9, v9
v_pk_add_f32 v[10:11], v[10:11], 1.0 op_sel_hi:[1,0]
v_rcp_f32 v10, v10
v_rcp_f32 v11, v11
v_pk_add_f32 v[12:13], v[12:13], 1.0 op_sel_hi:[1,0]
v_rcp_f32 v12, v12
v_rcp_f32 v13, v13
v_pk_mul_f32 v[6:7], v[6:7], v[28:29]
v_cvt_pk_f16_f32 v104, v6, v7
v_pk_add_u16 v104, v104, s60
v_and_b32 v104, 0xfff8fff8, v104
v_pk_mul_f32 v[8:9], v[8:9], v[30:31]
v_cvt_pk_f16_f32 v105, v8, v9
v_pk_add_u16 v105, v105, s60
v_and_b32 v105, 0xfff8fff8, v105
v_pk_mul_f32 v[10:11], v[10:11], v[44:45]
v_cvt_pk_f16_f32 v106, v10, v11
v_pk_add_u16 v106, v106, s60
v_and_b32 v106, 0xfff8fff8, v106
v_pk_mul_f32 v[12:13], v[12:13], v[46:47]
v_cvt_pk_f16_f32 v107, v12, v13
v_pk_add_u16 v107, v107, s60
v_and_b32 v107, 0xfff8fff8, v107
s_add_u32 s37, s36, 3072
buffer_store_dwordx4 v[104:107], v5, s[20:23], s37 offen sc1
v_pk_fma_f32 v[60:61], v[60:61], v[86:87], v[86:87] op_sel:[0,0,1] op_sel_hi:[1,0,1]
v_exp_f32 v6, v60
v_exp_f32 v7, v61
v_pk_fma_f32 v[62:63], v[62:63], v[86:87], v[86:87] op_sel:[0,0,1] op_sel_hi:[1,0,1]
v_exp_f32 v8, v62
v_exp_f32 v9, v63
v_pk_fma_f32 v[76:77], v[76:77], v[86:87], v[86:87] op_sel:[0,0,1] op_sel_hi:[1,0,1]
v_exp_f32 v10, v76
v_exp_f32 v11, v77
v_pk_fma_f32 v[78:79], v[78:79], v[86:87], v[86:87] op_sel:[0,0,1] op_sel_hi:[1,0,1]
v_exp_f32 v12, v78
v_exp_f32 v13, v79
v_pk_add_f32 v[6:7], v[6:7], 1.0 op_sel_hi:[1,0]
v_rcp_f32 v6, v6
v_rcp_f32 v7, v7
v_pk_add_f32 v[8:9], v[8:9], 1.0 op_sel_hi:[1,0]
v_rcp_f32 v8, v8
v_rcp_f32 v9, v9
v_pk_add_f32 v[10:11], v[10:11], 1.0 op_sel_hi:[1,0]
v_rcp_f32 v10, v10
v_rcp_f32 v11, v11
v_pk_add_f32 v[12:13], v[12:13], 1.0 op_sel_hi:[1,0]
v_rcp_f32 v12, v12
v_rcp_f32 v13, v13
v_pk_mul_f32 v[6:7], v[6:7], v[60:61]
v_cvt_pk_f16_f32 v108, v6, v7
v_pk_add_u16 v108, v108, s60
v_and_b32 v108, 0xfff8fff8, v108
v_pk_mul_f32 v[8:9], v[8:9], v[62:63]
v_cvt_pk_f16_f32 v109, v8, v9
v_pk_add_u16 v109, v109, s60
v_and_b32 v109, 0xfff8fff8, v109
v_pk_mul_f32 v[10:11], v[10:11], v[76:77]
v_cvt_pk_f16_f32 v110, v10, v11
v_pk_add_u16 v110, v110, s60
v_and_b32 v110, 0xfff8fff8, v110
v_pk_mul_f32 v[12:13], v[12:13], v[78:79]
v_cvt_pk_f16_f32 v111, v12, v13
v_pk_add_u16 v111, v111, s60
v_and_b32 v111, 0xfff8fff8, v111
s_add_u32 s37, s36, 527360
buffer_store_dwordx4 v[108:111], v5, s[20:23], s37 offen sc1
s_endpgm
cn_k1_kernel_c:
s_load_dwordx4 s[64:67], s[0:1], 16
v_lshlrev_b32 v210, 7, v1
v_and_b32 v211, 3, v1
v_lshrrev_b32 v212, 2, v1
v_lshlrev_b32 v211, 7, v211
v_lshl_add_u32 v211, v212, 10, v211
v_add_u32 v211, 512, v211
v_and_b32 v209, 1, v1
v_lshrrev_b32 v212, 1, v1
v_lshlrev_b32 v209, 7, v209
v_lshl_add_u32 v209, v212, 10, v209
v_add_u32 v209, 256, v209
s_sub_u32 s72, s25, 16
s_lshl_b32 s73, s26, 20
s_waitcnt lgkmcnt(0)
s_mov_b32 s68, s66
s_mov_b32 s69, s67
s_mov_b32 s70, 524288
s_mov_b32 s71, 0x20000
s_mov_b32 s66, 8388608
s_mov_b32 s67, 0x20000
s_sub_u32 s74, s24, 0
s_and_b32 s74, s74, 7
s_mul_i32 s75, s72, 1
s_add_u32 s75, s75, s74
s_lshl_b32 s75, s75, 13
s_add_u32 s75, s75, 0
s_cmp_ge_u32 s74, 1
s_cbranch_scc1 cn_k1_kernel_c_h0
buffer_load_dword v213, v210, s[68:71], s75 offen
cn_k1_kernel_c_h0:
s_barrier
s_sub_u32 s74, s24, 1
s_and_b32 s74, s74, 7
s_mul_i32 s75, s72, 2
s_add_u32 s75, s75, s74
s_lshl_b32 s75, s75, 15
s_add_u32 s75, s75, 0
s_add_u32 s75, s75, s73
s_cmp_ge_u32 s74, 2
s_cbranch_scc1 cn_k1_kernel_c_h1
buffer_load_dword v213, v209, s[64:67], s75 offen
cn_k1_kernel_c_h1:
s_waitcnt vmcnt(0)
s_barrier
s_sub_u32 s74, s24, 3
s_and_b32 s74, s74, 7
s_mul_i32 s75, s72, 3
s_add_u32 s75, s75, s74
s_lshl_b32 s75, s75, 13
s_add_u32 s75, s75, 131072
s_cmp_ge_u32 s74, 3
s_cbranch_scc1 cn_k1_kernel_c_h2
buffer_load_dword v213, v210, s[68:71], s75 offen
cn_k1_kernel_c_h2:
s_barrier
s_sub_u32 s74, s24, 6
s_and_b32 s74, s74, 7
s_mul_i32 s75, s72, 4
s_add_u32 s75, s75, s74
s_lshl_b32 s75, s75, 14
s_add_u32 s75, s75, 0
s_add_u32 s75, s75, s73
s_cmp_ge_u32 s74, 4
s_cbranch_scc1 cn_k1_kernel_c_h3
buffer_load_dword v213, v211, s[64:67], s75 offen
cn_k1_kernel_c_h3:
s_barrier
s_sub_u32 s74, s24, 2
s_and_b32 s74, s74, 7
s_mul_i32 s75, s72, 4
s_add_u32 s75, s75, s74
s_lshl_b32 s75, s75, 13
s_add_u32 s75, s75, 0
s_add_u32 s75, s75, s73
s_cmp_ge_u32 s74, 4
s_cbranch_scc1 cn_k1_kernel_c_h4
buffer_load_dword v213, v210, s[12:15], s75 offen
cn_k1_kernel_c_h4:
s_barrier
s_load_dwordx2 s[4:5], s[0:1], 40
s_load_dwordx2 s[8:9], s[0:1], 32
s_sub_u32 s29, s25, 16
s_lshr_b32 s28, s29, 2
s_and_b32 s29, s29, 3
s_mov_b32 s6, 4718592
s_mov_b32 s7, 0x20000
s_mov_b32 s10, 524288
s_mov_b32 s11, 0x20000
s_lshl_b32 s30, s29, 1
s_mul_i32 s36, s28, 3
s_add_u32 s30, s30, s36
s_and_b32 s30, s30, 7
v_lshrrev_b32 v116, 3, v1
v_and_b32 v117, 7, v1
v_lshrrev_b32 v118, 4, v1
s_and_b32 s36, s24, 1
s_lshl_b32 s36, s36, 2
v_xor_b32 v119, v117, v118
v_xor_b32 v119, s36, v119
v_lshlrev_b32 v2, 10, v116
v_lshl_add_u32 v2, v119, 4, v2
s_mul_i32 s36, s28, 1572864
s_lshl_b32 s37, s26, 16
s_add_u32 s36, s36, s37
s_lshl_b32 s37, s24, 13
s_add_u32 s36, s36, s37
v_add_u32 v2, s36, v2
v_add_u32 v3, 524288, v2
v_add_u32 v4, 1048576, v2
v_and_b32 v119, 15, v1
s_and_b32 s36, s24, 1
s_lshl_b32 s36, s36, 3
v_lshlrev_b32 v116, 1, v118
v_xor_b32 v116, s36, v116
v_xor_b32 v116, v116, v119
v_lshlrev_b32 v5, 10, v118
v_lshl_add_u32 v5, v116, 4, v5
s_lshl_b32 s36, s24, 13
s_lshl_b32 s37, s29, 8
s_add_u32 s36, s36, s37
v_add_u32 v5, s36, v5
v_add_u32 v6, 3072, v5
s_lshl_b32 s34, s24, 10
s_waitcnt lgkmcnt(0)
s_lshl_b32 s31, s30, 7
s_lshl_b32 s32, s30, 16
s_add_u32 m0, s34, 0
s_nop 0
buffer_load_dwordx4 v2, s[4:7], s31 offen lds
s_add_u32 m0, s34, 8192
s_nop 0
buffer_load_dwordx4 v3, s[4:7], s31 offen lds
s_add_u32 m0, s34, 16384
s_nop 0
buffer_load_dwordx4 v4, s[4:7], s31 offen lds
s_lshl_b32 s36, s34, 1
s_add_u32 m0, s36, 24576
s_nop 0
buffer_load_dwordx4 v5, s[8:11], s32 offen offset:0 lds
buffer_load_dwordx4 v6, s[8:11], s32 offen offset:1024 lds
s_add_u32 s30, s30, 1
s_and_b32 s30, s30, 7
v_lshrrev_b32 v117, 1, v119
v_xor_b32 v117, v117, v118
v_lshlrev_b32 v8, 7, v119
v_lshl_add_u32 v8, v117, 4, v8
s_lshr_b32 s36, s24, 2
s_lshl_b32 s37, s36, 12
v_add_u32 v8, s37, v8
v_xor_b32 v9, 64, v8
v_lshrrev_b32 v116, 2, v119
v_and_b32 v117, 3, v119
v_lshlrev_b32 v117, 3, v117
v_add_u32 v117, 24576, v117
s_and_b32 s37, s24, 3
s_lshl_b32 s37, s37, 1
v_lshl_add_u32 v10, v118, 3, v116
v_lshl_add_u32 v10, v10, 8, v117
v_and_b32 v11, 1, v118
v_lshl_add_u32 v11, v11, 2, v116
v_xor_b32 v11, s37, v11
v_lshl_add_u32 v10, v11, 5, v10
v_xor_b32 v11, 32, v10
v_lshl_add_u32 v12, v118, 2, v116
v_lshl_add_u32 v12, v12, 8, v117
s_lshl_b32 s36, s36, 13
s_add_u32 s36, s36, 98304
v_add_u32 v12, s36, v12
v_lshrrev_b32 v13, 1, v118
v_lshl_add_u32 v13, v13, 2, v116
v_xor_b32 v13, s37, v13
v_lshl_add_u32 v12, v13, 5, v12
v_xor_b32 v13, 32, v12
s_barrier
s_lshl_b32 s31, s30, 7
s_lshl_b32 s32, s30, 16
s_add_u32 m0, s34, 40960
s_nop 0
buffer_load_dwordx4 v2, s[4:7], s31 offen lds
s_add_u32 m0, s34, 49152
s_nop 0
buffer_load_dwordx4 v3, s[4:7], s31 offen lds
s_add_u32 m0, s34, 57344
s_nop 0
buffer_load_dwordx4 v4, s[4:7], s31 offen lds
s_lshl_b32 s36, s34, 1
s_add_u32 m0, s36, 65536
s_nop 0
buffer_load_dwordx4 v5, s[8:11], s32 offen offset:0 lds
buffer_load_dwordx4 v6, s[8:11], s32 offen offset:1024 lds
s_add_u32 s30, s30, 1
s_and_b32 s30, s30, 7
s_waitcnt vmcnt(5)
s_barrier
ds_read_b64_tr_b16 v[96:97], v10 offset:0
ds_read_b64_tr_b16 v[98:99], v10 offset:1024
ds_read_b64_tr_b16 v[100:101], v11 offset:0
ds_read_b64_tr_b16 v[102:103], v11 offset:1024
ds_read_b128 v[72:75], v8 offset:0
ds_read_b128 v[76:79], v8 offset:2048
ds_read_b128 v[80:83], v8 offset:8192
ds_read_b128 v[84:87], v8 offset:10240
ds_read_b128 v[88:91], v8 offset:16384
ds_read_b128 v[92:95], v8 offset:18432
ds_read_b64_tr_b16 v[128:129], v10 offset:8192
ds_read_b64_tr_b16 v[130:131], v10 offset:9216
ds_read_b64_tr_b16 v[132:133], v11 offset:8192
ds_read_b64_tr_b16 v[134:135], v11 offset:9216
s_lshl_b32 s36, s34, 1
s_add_u32 m0, s36, 122880
s_lshl_b32 s36, s26, 16
s_cmp_lg_u32 s28, 1
s_cbranch_scc1 cn_k1_kernel_nzd
buffer_load_dwordx4 v5, s[8:11], s36 offen offset:0 lds
buffer_load_dwordx4 v6, s[8:11], s36 offen offset:1024 lds
cn_k1_kernel_nzd:
s_lshl_b32 s31, s30, 7
s_lshl_b32 s32, s30, 16
s_add_u32 m0, s34, 81920
s_nop 0
buffer_load_dwordx4 v2, s[4:7], s31 offen lds
s_add_u32 m0, s34, 90112
s_nop 0
buffer_load_dwordx4 v3, s[4:7], s31 offen lds
s_add_u32 m0, s34, 98304
s_nop 0
buffer_load_dwordx4 v4, s[4:7], s31 offen lds
s_lshl_b32 s36, s34, 1
s_add_u32 m0, s36, 106496
s_nop 0
buffer_load_dwordx4 v5, s[8:11], s32 offen offset:0 lds
buffer_load_dwordx4 v6, s[8:11], s32 offen offset:1024 lds
s_add_u32 s30, s30, 1
s_and_b32 s30, s30, 7
s_waitcnt lgkmcnt(4)
ds_read_b128 v[104:107], v9 offset:0
ds_read_b128 v[108:111], v9 offset:2048
ds_read_b128 v[112:115], v9 offset:8192
ds_read_b128 v[116:119], v9 offset:10240
ds_read_b128 v[120:123], v9 offset:16384
ds_read_b128 v[124:127], v9 offset:18432
s_waitcnt vmcnt(5) lgkmcnt(0)
s_barrier
v_add_u32 v10, 40960, v10
v_add_u32 v11, 40960, v11
v_mfma_f32_16x16x32_bf16 v[16:19], v[72:75], v[96:99], 0
v_add_u32 v8, 40960, v8
ds_read_b64_tr_b16 v[160:161], v10 offset:0
v_mfma_f32_16x16x32_bf16 v[16:19], v[104:107], v[128:131], v[16:19]
ds_read_b64_tr_b16 v[162:163], v10 offset:1024
v_add_u32 v9, 40960, v9
v_mfma_f32_16x16x32_bf16 v[20:23], v[104:107], v[132:135], 0
s_lshl_b32 s31, s30, 7
ds_read_b64_tr_b16 v[164:165], v11 offset:0
v_mfma_f32_16x16x32_bf16 v[20:23], v[72:75], v[100:103], v[20:23]
s_lshl_b32 s32, s30, 16
ds_read_b64_tr_b16 v[166:167], v11 offset:1024
v_mfma_f32_16x16x32_bf16 v[24:27], v[76:79], v[96:99], 0
s_add_u32 m0, s34, 0
ds_read_b128 v[136:139], v8 offset:0
v_mfma_f32_16x16x32_bf16 v[24:27], v[108:111], v[128:131], v[24:27]
s_nop 0
ds_read_b128 v[140:143], v8 offset:2048
v_mfma_f32_16x16x32_bf16 v[28:31], v[108:111], v[132:135], 0
buffer_load_dwordx4 v2, s[4:7], s31 offen lds
ds_read_b128 v[144:147], v8 offset:8192
v_mfma_f32_16x16x32_bf16 v[28:31], v[76:79], v[100:103], v[28:31]
s_add_u32 m0, s34, 8192
ds_read_b128 v[148:151], v8 offset:10240
v_mfma_f32_16x16x32_bf16 v[32:35], v[80:83], v[96:99], 0
s_nop 0
ds_read_b128 v[152:155], v8 offset:16384
v_mfma_f32_16x16x32_bf16 v[32:35], v[112:115], v[128:131], v[32:35]
buffer_load_dwordx4 v3, s[4:7], s31 offen lds
ds_read_b128 v[156:159], v8 offset:18432
v_mfma_f32_16x16x32_bf16 v[36:39], v[112:115], v[132:135], 0
s_add_u32 m0, s34, 16384
ds_read_b64_tr_b16 v[192:193], v10 offset:8192
v_mfma_f32_16x16x32_bf16 v[36:39], v[80:83], v[100:103], v[36:39]
s_nop 0
ds_read_b64_tr_b16 v[194:195], v10 offset:9216
v_mfma_f32_16x16x32_bf16 v[40:43], v[84:87], v[96:99], 0
buffer_load_dwordx4 v4, s[4:7], s31 offen lds
ds_read_b64_tr_b16 v[196:197], v11 offset:8192
v_mfma_f32_16x16x32_bf16 v[40:43], v[116:119], v[128:131], v[40:43]
s_lshl_b32 s36, s34, 1
ds_read_b64_tr_b16 v[198:199], v11 offset:9216
v_mfma_f32_16x16x32_bf16 v[44:47], v[116:119], v[132:135], 0
s_add_u32 m0, s36, 24576
s_waitcnt lgkmcnt(9)
v_mfma_f32_16x16x32_bf16 v[44:47], v[84:87], v[100:103], v[44:47]
ds_read_b128 v[168:171], v9 offset:0
s_nop 0
v_mfma_f32_16x16x32_bf16 v[48:51], v[88:91], v[96:99], 0
ds_read_b128 v[172:175], v9 offset:2048
buffer_load_dwordx4 v5, s[8:11], s32 offen offset:0 lds
v_mfma_f32_16x16x32_bf16 v[48:51], v[120:123], v[128:131], v[48:51]
ds_read_b128 v[176:179], v9 offset:8192
buffer_load_dwordx4 v6, s[8:11], s32 offen offset:1024 lds
v_mfma_f32_16x16x32_bf16 v[52:55], v[120:123], v[132:135], 0
ds_read_b128 v[180:183], v9 offset:10240
s_add_u32 s30, s30, 1
v_mfma_f32_16x16x32_bf16 v[52:55], v[88:91], v[100:103], v[52:55]
ds_read_b128 v[184:187], v9 offset:16384
s_and_b32 s30, s30, 7
v_mfma_f32_16x16x32_bf16 v[56:59], v[92:95], v[96:99], 0
ds_read_b128 v[188:191], v9 offset:18432
v_mfma_f32_16x16x32_bf16 v[56:59], v[124:127], v[128:131], v[56:59]
v_mfma_f32_16x16x32_bf16 v[60:63], v[124:127], v[132:135], 0
v_mfma_f32_16x16x32_bf16 v[60:63], v[92:95], v[100:103], v[60:63]
s_waitcnt vmcnt(5) lgkmcnt(0)
s_barrier
v_add_u32 v10, 40960, v10
v_add_u32 v11, 40960, v11
v_mfma_f32_16x16x32_bf16 v[16:19], v[136:139], v[160:163], v[16:19]
v_add_u32 v8, 40960, v8
ds_read_b64_tr_b16 v[96:97], v10 offset:0
v_mfma_f32_16x16x32_bf16 v[16:19], v[168:171], v[192:195], v[16:19]
ds_read_b64_tr_b16 v[98:99], v10 offset:1024
v_add_u32 v9, 40960, v9
v_mfma_f32_16x16x32_bf16 v[20:23], v[168:171], v[196:199], v[20:23]
s_lshl_b32 s31, s30, 7
ds_read_b64_tr_b16 v[100:101], v11 offset:0
v_mfma_f32_16x16x32_bf16 v[20:23], v[136:139], v[164:167], v[20:23]
s_lshl_b32 s32, s30, 16
ds_read_b64_tr_b16 v[102:103], v11 offset:1024
v_mfma_f32_16x16x32_bf16 v[24:27], v[140:143], v[160:163], v[24:27]
s_add_u32 m0, s34, 40960
ds_read_b128 v[72:75], v8 offset:0
v_mfma_f32_16x16x32_bf16 v[24:27], v[172:175], v[192:195], v[24:27]
s_nop 0
ds_read_b128 v[76:79], v8 offset:2048
v_mfma_f32_16x16x32_bf16 v[28:31], v[172:175], v[196:199], v[28:31]
buffer_load_dwordx4 v2, s[4:7], s31 offen lds
ds_read_b128 v[80:83], v8 offset:8192
v_mfma_f32_16x16x32_bf16 v[28:31], v[140:143], v[164:167], v[28:31]
s_add_u32 m0, s34, 49152
ds_read_b128 v[84:87], v8 offset:10240
v_mfma_f32_16x16x32_bf16 v[32:35], v[144:147], v[160:163], v[32:35]
s_nop 0
ds_read_b128 v[88:91], v8 offset:16384
v_mfma_f32_16x16x32_bf16 v[32:35], v[176:179], v[192:195], v[32:35]
buffer_load_dwordx4 v3, s[4:7], s31 offen lds
ds_read_b128 v[92:95], v8 offset:18432
v_mfma_f32_16x16x32_bf16 v[36:39], v[176:179], v[196:199], v[36:39]
s_add_u32 m0, s34, 57344
ds_read_b64_tr_b16 v[128:129], v10 offset:8192
v_mfma_f32_16x16x32_bf16 v[36:39], v[144:147], v[164:167], v[36:39]
s_nop 0
ds_read_b64_tr_b16 v[130:131], v10 offset:9216
v_mfma_f32_16x16x32_bf16 v[40:43], v[148:151], v[160:163], v[40:43]
buffer_load_dwordx4 v4, s[4:7], s31 offen lds
ds_read_b64_tr_b16 v[132:133], v11 offset:8192
v_mfma_f32_16x16x32_bf16 v[40:43], v[180:183], v[192:195], v[40:43]
s_lshl_b32 s36, s34, 1
ds_read_b64_tr_b16 v[134:135], v11 offset:9216
v_mfma_f32_16x16x32_bf16 v[44:47], v[180:183], v[196:199], v[44:47]
s_add_u32 m0, s36, 65536
s_waitcnt lgkmcnt(9)
v_mfma_f32_16x16x32_bf16 v[44:47], v[148:151], v[164:167], v[44:47]
ds_read_b128 v[104:107], v9 offset:0
s_nop 0
v_mfma_f32_16x16x32_bf16 v[48:51], v[152:155], v[160:163], v[48:51]
ds_read_b128 v[108:111], v9 offset:2048
buffer_load_dwordx4 v5, s[8:11], s32 offen offset:0 lds
v_mfma_f32_16x16x32_bf16 v[48:51], v[184:187], v[192:195], v[48:51]
ds_read_b128 v[112:115], v9 offset:8192
buffer_load_dwordx4 v6, s[8:11], s32 offen offset:1024 lds
v_mfma_f32_16x16x32_bf16 v[52:55], v[184:187], v[196:199], v[52:55]
ds_read_b128 v[116:119], v9 offset:10240
s_add_u32 s30, s30, 1
v_mfma_f32_16x16x32_bf16 v[52:55], v[152:155], v[164:167], v[52:55]
ds_read_b128 v[120:123], v9 offset:16384
s_and_b32 s30, s30, 7
v_mfma_f32_16x16x32_bf16 v[56:59], v[156:159], v[160:163], v[56:59]
ds_read_b128 v[124:127], v9 offset:18432
v_mfma_f32_16x16x32_bf16 v[56:59], v[188:191], v[192:195], v[56:59]
v_mfma_f32_16x16x32_bf16 v[60:63], v[188:191], v[196:199], v[60:63]
v_mfma_f32_16x16x32_bf16 v[60:63], v[156:159], v[164:167], v[60:63]
s_waitcnt vmcnt(5) lgkmcnt(0)
s_barrier
v_add_u32 v10, 4294885376, v10
v_add_u32 v11, 4294885376, v11
v_mfma_f32_16x16x32_bf16 v[16:19], v[72:75], v[96:99], v[16:19]
v_add_u32 v8, 4294885376, v8
ds_read_b64_tr_b16 v[160:161], v10 offset:0
v_mfma_f32_16x16x32_bf16 v[16:19], v[104:107], v[128:131], v[16:19]
ds_read_b64_tr_b16 v[162:163], v10 offset:1024
v_add_u32 v9, 4294885376, v9
v_mfma_f32_16x16x32_bf16 v[20:23], v[104:107], v[132:135], v[20:23]
s_lshl_b32 s31, s30, 7
ds_read_b64_tr_b16 v[164:165], v11 offset:0
v_mfma_f32_16x16x32_bf16 v[20:23], v[72:75], v[100:103], v[20:23]
s_lshl_b32 s32, s30, 16
ds_read_b64_tr_b16 v[166:167], v11 offset:1024
v_mfma_f32_16x16x32_bf16 v[24:27], v[76:79], v[96:99], v[24:27]
s_add_u32 m0, s34, 81920
ds_read_b128 v[136:139], v8 offset:0
v_mfma_f32_16x16x32_bf16 v[24:27], v[108:111], v[128:131], v[24:27]
s_nop 0
ds_read_b128 v[140:143], v8 offset:2048
v_mfma_f32_16x16x32_bf16 v[28:31], v[108:111], v[132:135], v[28:31]
buffer_load_dwordx4 v2, s[4:7], s31 offen lds
ds_read_b128 v[144:147], v8 offset:8192
v_mfma_f32_16x16x32_bf16 v[28:31], v[76:79], v[100:103], v[28:31]
s_add_u32 m0, s34, 90112
ds_read_b128 v[148:151], v8 offset:10240
v_mfma_f32_16x16x32_bf16 v[32:35], v[80:83], v[96:99], v[32:35]
s_nop 0
ds_read_b128 v[152:155], v8 offset:16384
v_mfma_f32_16x16x32_bf16 v[32:35], v[112:115], v[128:131], v[32:35]
buffer_load_dwordx4 v3, s[4:7], s31 offen lds
ds_read_b128 v[156:159], v8 offset:18432
v_mfma_f32_16x16x32_bf16 v[36:39], v[112:115], v[132:135], v[36:39]
s_add_u32 m0, s34, 98304
ds_read_b64_tr_b16 v[192:193], v10 offset:8192
v_mfma_f32_16x16x32_bf16 v[36:39], v[80:83], v[100:103], v[36:39]
s_nop 0
ds_read_b64_tr_b16 v[194:195], v10 offset:9216
v_mfma_f32_16x16x32_bf16 v[40:43], v[84:87], v[96:99], v[40:43]
buffer_load_dwordx4 v4, s[4:7], s31 offen lds
ds_read_b64_tr_b16 v[196:197], v11 offset:8192
v_mfma_f32_16x16x32_bf16 v[40:43], v[116:119], v[128:131], v[40:43]
s_lshl_b32 s36, s34, 1
ds_read_b64_tr_b16 v[198:199], v11 offset:9216
v_mfma_f32_16x16x32_bf16 v[44:47], v[116:119], v[132:135], v[44:47]
s_add_u32 m0, s36, 106496
s_waitcnt lgkmcnt(9)
v_mfma_f32_16x16x32_bf16 v[44:47], v[84:87], v[100:103], v[44:47]
ds_read_b128 v[168:171], v9 offset:0
s_nop 0
v_mfma_f32_16x16x32_bf16 v[48:51], v[88:91], v[96:99], v[48:51]
ds_read_b128 v[172:175], v9 offset:2048
buffer_load_dwordx4 v5, s[8:11], s32 offen offset:0 lds
v_mfma_f32_16x16x32_bf16 v[48:51], v[120:123], v[128:131], v[48:51]
ds_read_b128 v[176:179], v9 offset:8192
buffer_load_dwordx4 v6, s[8:11], s32 offen offset:1024 lds
v_mfma_f32_16x16x32_bf16 v[52:55], v[120:123], v[132:135], v[52:55]
ds_read_b128 v[180:183], v9 offset:10240
s_add_u32 s30, s30, 1
v_mfma_f32_16x16x32_bf16 v[52:55], v[88:91], v[100:103], v[52:55]
ds_read_b128 v[184:187], v9 offset:16384
s_and_b32 s30, s30, 7
v_mfma_f32_16x16x32_bf16 v[56:59], v[92:95], v[96:99], v[56:59]
ds_read_b128 v[188:191], v9 offset:18432
v_mfma_f32_16x16x32_bf16 v[56:59], v[124:127], v[128:131], v[56:59]
v_mfma_f32_16x16x32_bf16 v[60:63], v[124:127], v[132:135], v[60:63]
v_mfma_f32_16x16x32_bf16 v[60:63], v[92:95], v[100:103], v[60:63]
s_waitcnt vmcnt(5) lgkmcnt(0)
s_barrier
v_add_u32 v10, 40960, v10
v_add_u32 v11, 40960, v11
v_mfma_f32_16x16x32_bf16 v[16:19], v[136:139], v[160:163], v[16:19]
v_add_u32 v8, 40960, v8
ds_read_b64_tr_b16 v[96:97], v10 offset:0
v_mfma_f32_16x16x32_bf16 v[16:19], v[168:171], v[192:195], v[16:19]
ds_read_b64_tr_b16 v[98:99], v10 offset:1024
v_add_u32 v9, 40960, v9
v_mfma_f32_16x16x32_bf16 v[20:23], v[168:171], v[196:199], v[20:23]
s_lshl_b32 s31, s30, 7
ds_read_b64_tr_b16 v[100:101], v11 offset:0
v_mfma_f32_16x16x32_bf16 v[20:23], v[136:139], v[164:167], v[20:23]
s_lshl_b32 s32, s30, 16
ds_read_b64_tr_b16 v[102:103], v11 offset:1024
v_mfma_f32_16x16x32_bf16 v[24:27], v[140:143], v[160:163], v[24:27]
s_add_u32 m0, s34, 0
ds_read_b128 v[72:75], v8 offset:0
v_mfma_f32_16x16x32_bf16 v[24:27], v[172:175], v[192:195], v[24:27]
s_nop 0
ds_read_b128 v[76:79], v8 offset:2048
v_mfma_f32_16x16x32_bf16 v[28:31], v[172:175], v[196:199], v[28:31]
buffer_load_dwordx4 v2, s[4:7], s31 offen lds
ds_read_b128 v[80:83], v8 offset:8192
v_mfma_f32_16x16x32_bf16 v[28:31], v[140:143], v[164:167], v[28:31]
s_add_u32 m0, s34, 8192
ds_read_b128 v[84:87], v8 offset:10240
v_mfma_f32_16x16x32_bf16 v[32:35], v[144:147], v[160:163], v[32:35]
s_nop 0
ds_read_b128 v[88:91], v8 offset:16384
v_mfma_f32_16x16x32_bf16 v[32:35], v[176:179], v[192:195], v[32:35]
buffer_load_dwordx4 v3, s[4:7], s31 offen lds
ds_read_b128 v[92:95], v8 offset:18432
v_mfma_f32_16x16x32_bf16 v[36:39], v[176:179], v[196:199], v[36:39]
s_add_u32 m0, s34, 16384
ds_read_b64_tr_b16 v[128:129], v10 offset:8192
v_mfma_f32_16x16x32_bf16 v[36:39], v[144:147], v[164:167], v[36:39]
s_nop 0
ds_read_b64_tr_b16 v[130:131], v10 offset:9216
v_mfma_f32_16x16x32_bf16 v[40:43], v[148:151], v[160:163], v[40:43]
buffer_load_dwordx4 v4, s[4:7], s31 offen lds
ds_read_b64_tr_b16 v[132:133], v11 offset:8192
v_mfma_f32_16x16x32_bf16 v[40:43], v[180:183], v[192:195], v[40:43]
s_lshl_b32 s36, s34, 1
ds_read_b64_tr_b16 v[134:135], v11 offset:9216
v_mfma_f32_16x16x32_bf16 v[44:47], v[180:183], v[196:199], v[44:47]
s_add_u32 m0, s36, 24576
s_waitcnt lgkmcnt(9)
v_mfma_f32_16x16x32_bf16 v[44:47], v[148:151], v[164:167], v[44:47]
ds_read_b128 v[104:107], v9 offset:0
s_nop 0
v_mfma_f32_16x16x32_bf16 v[48:51], v[152:155], v[160:163], v[48:51]
ds_read_b128 v[108:111], v9 offset:2048
buffer_load_dwordx4 v5, s[8:11], s32 offen offset:0 lds
v_mfma_f32_16x16x32_bf16 v[48:51], v[184:187], v[192:195], v[48:51]
ds_read_b128 v[112:115], v9 offset:8192
buffer_load_dwordx4 v6, s[8:11], s32 offen offset:1024 lds
v_mfma_f32_16x16x32_bf16 v[52:55], v[184:187], v[196:199], v[52:55]
ds_read_b128 v[116:119], v9 offset:10240
s_add_u32 s30, s30, 1
v_mfma_f32_16x16x32_bf16 v[52:55], v[152:155], v[164:167], v[52:55]
ds_read_b128 v[120:123], v9 offset:16384
s_and_b32 s30, s30, 7
v_mfma_f32_16x16x32_bf16 v[56:59], v[156:159], v[160:163], v[56:59]
ds_read_b128 v[124:127], v9 offset:18432
v_mfma_f32_16x16x32_bf16 v[56:59], v[188:191], v[192:195], v[56:59]
v_mfma_f32_16x16x32_bf16 v[60:63], v[188:191], v[196:199], v[60:63]
v_mfma_f32_16x16x32_bf16 v[60:63], v[156:159], v[164:167], v[60:63]
s_waitcnt vmcnt(5) lgkmcnt(0)
s_barrier
v_add_u32 v10, 40960, v10
v_add_u32 v11, 40960, v11
v_mfma_f32_16x16x32_bf16 v[16:19], v[72:75], v[96:99], v[16:19]
v_add_u32 v8, 40960, v8
ds_read_b64_tr_b16 v[160:161], v10 offset:0
v_mfma_f32_16x16x32_bf16 v[16:19], v[104:107], v[128:131], v[16:19]
ds_read_b64_tr_b16 v[162:163], v10 offset:1024
v_add_u32 v9, 40960, v9
v_mfma_f32_16x16x32_bf16 v[20:23], v[104:107], v[132:135], v[20:23]
s_lshl_b32 s31, s30, 7
ds_read_b64_tr_b16 v[164:165], v11 offset:0
v_mfma_f32_16x16x32_bf16 v[20:23], v[72:75], v[100:103], v[20:23]
s_lshl_b32 s32, s30, 16
ds_read_b64_tr_b16 v[166:167], v11 offset:1024
v_mfma_f32_16x16x32_bf16 v[24:27], v[76:79], v[96:99], v[24:27]
s_add_u32 m0, s34, 40960
ds_read_b128 v[136:139], v8 offset:0
v_mfma_f32_16x16x32_bf16 v[24:27], v[108:111], v[128:131], v[24:27]
s_nop 0
ds_read_b128 v[140:143], v8 offset:2048
v_mfma_f32_16x16x32_bf16 v[28:31], v[108:111], v[132:135], v[28:31]
buffer_load_dwordx4 v2, s[4:7], s31 offen lds
ds_read_b128 v[144:147], v8 offset:8192
v_mfma_f32_16x16x32_bf16 v[28:31], v[76:79], v[100:103], v[28:31]
s_add_u32 m0, s34, 49152
ds_read_b128 v[148:151], v8 offset:10240
v_mfma_f32_16x16x32_bf16 v[32:35], v[80:83], v[96:99], v[32:35]
s_nop 0
ds_read_b128 v[152:155], v8 offset:16384
v_mfma_f32_16x16x32_bf16 v[32:35], v[112:115], v[128:131], v[32:35]
buffer_load_dwordx4 v3, s[4:7], s31 offen lds
ds_read_b128 v[156:159], v8 offset:18432
v_mfma_f32_16x16x32_bf16 v[36:39], v[112:115], v[132:135], v[36:39]
s_add_u32 m0, s34, 57344
ds_read_b64_tr_b16 v[192:193], v10 offset:8192
v_mfma_f32_16x16x32_bf16 v[36:39], v[80:83], v[100:103], v[36:39]
s_nop 0
ds_read_b64_tr_b16 v[194:195], v10 offset:9216
v_mfma_f32_16x16x32_bf16 v[40:43], v[84:87], v[96:99], v[40:43]
buffer_load_dwordx4 v4, s[4:7], s31 offen lds
ds_read_b64_tr_b16 v[196:197], v11 offset:8192
v_mfma_f32_16x16x32_bf16 v[40:43], v[116:119], v[128:131], v[40:43]
s_lshl_b32 s36, s34, 1
ds_read_b64_tr_b16 v[198:199], v11 offset:9216
v_mfma_f32_16x16x32_bf16 v[44:47], v[116:119], v[132:135], v[44:47]
s_add_u32 m0, s36, 65536
s_waitcnt lgkmcnt(9)
v_mfma_f32_16x16x32_bf16 v[44:47], v[84:87], v[100:103], v[44:47]
ds_read_b128 v[168:171], v9 offset:0
s_nop 0
v_mfma_f32_16x16x32_bf16 v[48:51], v[88:91], v[96:99], v[48:51]
ds_read_b128 v[172:175], v9 offset:2048
buffer_load_dwordx4 v5, s[8:11], s32 offen offset:0 lds
v_mfma_f32_16x16x32_bf16 v[48:51], v[120:123], v[128:131], v[48:51]
ds_read_b128 v[176:179], v9 offset:8192
buffer_load_dwordx4 v6, s[8:11], s32 offen offset:1024 lds
v_mfma_f32_16x16x32_bf16 v[52:55], v[120:123], v[132:135], v[52:55]
ds_read_b128 v[180:183], v9 offset:10240
s_add_u32 s30, s30, 1
v_mfma_f32_16x16x32_bf16 v[52:55], v[88:91], v[100:103], v[52:55]
ds_read_b128 v[184:187], v9 offset:16384
s_and_b32 s30, s30, 7
v_mfma_f32_16x16x32_bf16 v[56:59], v[92:95], v[96:99], v[56:59]
ds_read_b128 v[188:191], v9 offset:18432
v_mfma_f32_16x16x32_bf16 v[56:59], v[124:127], v[128:131], v[56:59]
v_mfma_f32_16x16x32_bf16 v[60:63], v[124:127], v[132:135], v[60:63]
v_mfma_f32_16x16x32_bf16 v[60:63], v[92:95], v[100:103], v[60:63]
s_waitcnt vmcnt(5) lgkmcnt(0)
s_barrier
v_add_u32 v10, 4294885376, v10
v_add_u32 v11, 4294885376, v11
v_mfma_f32_16x16x32_bf16 v[16:19], v[136:139], v[160:163], v[16:19]
v_add_u32 v8, 4294885376, v8
ds_read_b64_tr_b16 v[96:97], v10 offset:0
v_mfma_f32_16x16x32_bf16 v[16:19], v[168:171], v[192:195], v[16:19]
ds_read_b64_tr_b16 v[98:99], v10 offset:1024
v_add_u32 v9, 4294885376, v9
v_mfma_f32_16x16x32_bf16 v[20:23], v[168:171], v[196:199], v[20:23]
ds_read_b64_tr_b16 v[100:101], v11 offset:0
v_mfma_f32_16x16x32_bf16 v[20:23], v[136:139], v[164:167], v[20:23]
ds_read_b64_tr_b16 v[102:103], v11 offset:1024
v_mfma_f32_16x16x32_bf16 v[24:27], v[140:143], v[160:163], v[24:27]
ds_read_b128 v[72:75], v8 offset:0
v_mfma_f32_16x16x32_bf16 v[24:27], v[172:175], v[192:195], v[24:27]
ds_read_b128 v[76:79], v8 offset:2048
v_mfma_f32_16x16x32_bf16 v[28:31], v[172:175], v[196:199], v[28:31]
ds_read_b128 v[80:83], v8 offset:8192
v_mfma_f32_16x16x32_bf16 v[28:31], v[140:143], v[164:167], v[28:31]
ds_read_b128 v[84:87], v8 offset:10240
v_mfma_f32_16x16x32_bf16 v[32:35], v[144:147], v[160:163], v[32:35]
ds_read_b128 v[88:91], v8 offset:16384
v_mfma_f32_16x16x32_bf16 v[32:35], v[176:179], v[192:195], v[32:35]
ds_read_b128 v[92:95], v8 offset:18432
v_mfma_f32_16x16x32_bf16 v[36:39], v[176:179], v[196:199], v[36:39]
ds_read_b64_tr_b16 v[128:129], v10 offset:8192
v_mfma_f32_16x16x32_bf16 v[36:39], v[144:147], v[164:167], v[36:39]
ds_read_b64_tr_b16 v[130:131], v10 offset:9216
v_mfma_f32_16x16x32_bf16 v[40:43], v[148:151], v[160:163], v[40:43]
ds_read_b64_tr_b16 v[132:133], v11 offset:8192
v_mfma_f32_16x16x32_bf16 v[40:43], v[180:183], v[192:195], v[40:43]
ds_read_b64_tr_b16 v[134:135], v11 offset:9216
v_mfma_f32_16x16x32_bf16 v[44:47], v[180:183], v[196:199], v[44:47]
s_waitcnt lgkmcnt(9)
ds_read_b128 v[104:107], v9 offset:0
v_mfma_f32_16x16x32_bf16 v[44:47], v[148:151], v[164:167], v[44:47]
ds_read_b128 v[108:111], v9 offset:2048
v_mfma_f32_16x16x32_bf16 v[48:51], v[152:155], v[160:163], v[48:51]
ds_read_b128 v[112:115], v9 offset:8192
v_mfma_f32_16x16x32_bf16 v[48:51], v[184:187], v[192:195], v[48:51]
ds_read_b128 v[116:119], v9 offset:10240
v_mfma_f32_16x16x32_bf16 v[52:55], v[184:187], v[196:199], v[52:55]
ds_read_b128 v[120:123], v9 offset:16384
v_mfma_f32_16x16x32_bf16 v[52:55], v[152:155], v[164:167], v[52:55]
ds_read_b128 v[124:127], v9 offset:18432
v_mfma_f32_16x16x32_bf16 v[56:59], v[156:159], v[160:163], v[56:59]
v_mfma_f32_16x16x32_bf16 v[56:59], v[188:191], v[192:195], v[56:59]
v_mfma_f32_16x16x32_bf16 v[60:63], v[188:191], v[196:199], v[60:63]
v_mfma_f32_16x16x32_bf16 v[60:63], v[156:159], v[164:167], v[60:63]
s_waitcnt vmcnt(0) lgkmcnt(0)
s_barrier
v_add_u32 v10, 40960, v10
v_add_u32 v11, 40960, v11
v_mfma_f32_16x16x32_bf16 v[16:19], v[72:75], v[96:99], v[16:19]
v_add_u32 v8, 40960, v8
ds_read_b64_tr_b16 v[160:161], v10 offset:0
v_mfma_f32_16x16x32_bf16 v[16:19], v[104:107], v[128:131], v[16:19]
ds_read_b64_tr_b16 v[162:163], v10 offset:1024
v_add_u32 v9, 40960, v9
v_mfma_f32_16x16x32_bf16 v[20:23], v[104:107], v[132:135], v[20:23]
ds_read_b64_tr_b16 v[164:165], v11 offset:0
v_mfma_f32_16x16x32_bf16 v[20:23], v[72:75], v[100:103], v[20:23]
ds_read_b64_tr_b16 v[166:167], v11 offset:1024
v_mfma_f32_16x16x32_bf16 v[24:27], v[76:79], v[96:99], v[24:27]
ds_read_b128 v[136:139], v8 offset:0
v_mfma_f32_16x16x32_bf16 v[24:27], v[108:111], v[128:131], v[24:27]
ds_read_b128 v[140:143], v8 offset:2048
v_mfma_f32_16x16x32_bf16 v[28:31], v[108:111], v[132:135], v[28:31]
ds_read_b128 v[144:147], v8 offset:8192
v_mfma_f32_16x16x32_bf16 v[28:31], v[76:79], v[100:103], v[28:31]
ds_read_b128 v[148:151], v8 offset:10240
v_mfma_f32_16x16x32_bf16 v[32:35], v[80:83], v[96:99], v[32:35]
ds_read_b128 v[152:155], v8 offset:16384
v_mfma_f32_16x16x32_bf16 v[32:35], v[112:115], v[128:131], v[32:35]
ds_read_b128 v[156:159], v8 offset:18432
v_mfma_f32_16x16x32_bf16 v[36:39], v[112:115], v[132:135], v[36:39]
ds_read_b64_tr_b16 v[192:193], v10 offset:8192
v_mfma_f32_16x16x32_bf16 v[36:39], v[80:83], v[100:103], v[36:39]
ds_read_b64_tr_b16 v[194:195], v10 offset:9216
v_mfma_f32_16x16x32_bf16 v[40:43], v[84:87], v[96:99], v[40:43]
ds_read_b64_tr_b16 v[196:197], v11 offset:8192
v_mfma_f32_16x16x32_bf16 v[40:43], v[116:119], v[128:131], v[40:43]
ds_read_b64_tr_b16 v[198:199], v11 offset:9216
v_mfma_f32_16x16x32_bf16 v[44:47], v[116:119], v[132:135], v[44:47]
s_waitcnt lgkmcnt(9)
ds_read_b128 v[168:171], v9 offset:0
v_mfma_f32_16x16x32_bf16 v[44:47], v[84:87], v[100:103], v[44:47]
ds_read_b128 v[172:175], v9 offset:2048
v_mfma_f32_16x16x32_bf16 v[48:51], v[88:91], v[96:99], v[48:51]
ds_read_b128 v[176:179], v9 offset:8192
v_mfma_f32_16x16x32_bf16 v[48:51], v[120:123], v[128:131], v[48:51]
ds_read_b128 v[180:183], v9 offset:10240
v_mfma_f32_16x16x32_bf16 v[52:55], v[120:123], v[132:135], v[52:55]
ds_read_b128 v[184:187], v9 offset:16384
v_mfma_f32_16x16x32_bf16 v[52:55], v[88:91], v[100:103], v[52:55]
ds_read_b128 v[188:191], v9 offset:18432
v_mfma_f32_16x16x32_bf16 v[56:59], v[92:95], v[96:99], v[56:59]
v_mfma_f32_16x16x32_bf16 v[56:59], v[124:127], v[128:131], v[56:59]
v_mfma_f32_16x16x32_bf16 v[60:63], v[124:127], v[132:135], v[60:63]
v_mfma_f32_16x16x32_bf16 v[60:63], v[92:95], v[100:103], v[60:63]
s_waitcnt lgkmcnt(0)
v_mfma_f32_16x16x32_bf16 v[16:19], v[136:139], v[160:163], v[16:19]
v_mfma_f32_16x16x32_bf16 v[16:19], v[168:171], v[192:195], v[16:19]
v_mfma_f32_16x16x32_bf16 v[20:23], v[168:171], v[196:199], v[20:23]
v_mfma_f32_16x16x32_bf16 v[20:23], v[136:139], v[164:167], v[20:23]
v_mfma_f32_16x16x32_bf16 v[24:27], v[140:143], v[160:163], v[24:27]
v_mfma_f32_16x16x32_bf16 v[24:27], v[172:175], v[192:195], v[24:27]
v_mfma_f32_16x16x32_bf16 v[28:31], v[172:175], v[196:199], v[28:31]
v_mfma_f32_16x16x32_bf16 v[28:31], v[140:143], v[164:167], v[28:31]
v_mfma_f32_16x16x32_bf16 v[32:35], v[144:147], v[160:163], v[32:35]
v_mfma_f32_16x16x32_bf16 v[32:35], v[176:179], v[192:195], v[32:35]
v_mfma_f32_16x16x32_bf16 v[36:39], v[176:179], v[196:199], v[36:39]
v_mfma_f32_16x16x32_bf16 v[36:39], v[144:147], v[164:167], v[36:39]
v_mfma_f32_16x16x32_bf16 v[40:43], v[148:151], v[160:163], v[40:43]
v_mfma_f32_16x16x32_bf16 v[40:43], v[180:183], v[192:195], v[40:43]
v_mfma_f32_16x16x32_bf16 v[44:47], v[180:183], v[196:199], v[44:47]
v_mfma_f32_16x16x32_bf16 v[44:47], v[148:151], v[164:167], v[44:47]
v_mfma_f32_16x16x32_bf16 v[48:51], v[152:155], v[160:163], v[48:51]
v_mfma_f32_16x16x32_bf16 v[48:51], v[184:187], v[192:195], v[48:51]
v_mfma_f32_16x16x32_bf16 v[52:55], v[184:187], v[196:199], v[52:55]
v_mfma_f32_16x16x32_bf16 v[52:55], v[152:155], v[164:167], v[52:55]
v_mfma_f32_16x16x32_bf16 v[56:59], v[156:159], v[160:163], v[56:59]
v_mfma_f32_16x16x32_bf16 v[56:59], v[188:191], v[192:195], v[56:59]
v_mfma_f32_16x16x32_bf16 v[60:63], v[188:191], v[196:199], v[60:63]
v_mfma_f32_16x16x32_bf16 v[60:63], v[156:159], v[164:167], v[60:63]
ds_read_b64_tr_b16 v[64:65], v12 offset:0
ds_read_b64_tr_b16 v[66:67], v12 offset:4096
ds_read_b64_tr_b16 v[68:69], v13 offset:0
ds_read_b64_tr_b16 v[70:71], v13 offset:4096
s_nop 3
v_mov_b32 v2, 0
v_mov_b32 v3, 0
v_pk_add_f32 v[4:5], v[16:17], v[48:49]
v_max3_f32 v2, abs(v16), abs(v17), v2
v_max3_f32 v2, abs(v48), abs(v49), v2
v_pk_add_f32 v[72:73], v[4:5], v[32:33]
v_pk_add_f32 v[88:89], v[4:5], v[32:33] neg_lo:[0,1] neg_hi:[0,1]
v_max3_f32 v3, abs(v72), abs(v73), v3
v_max3_f32 v3, abs(v88), abs(v89), v3
v_pk_add_f32 v[4:5], v[18:19], v[50:51]
v_max3_f32 v2, abs(v18), abs(v19), v2
v_max3_f32 v2, abs(v50), abs(v51), v2
v_pk_add_f32 v[74:75], v[4:5], v[34:35]
v_pk_add_f32 v[90:91], v[4:5], v[34:35] neg_lo:[0,1] neg_hi:[0,1]
v_max3_f32 v3, abs(v74), abs(v75), v3
v_max3_f32 v3, abs(v90), abs(v91), v3
v_pk_add_f32 v[4:5], v[20:21], v[52:53]
v_max3_f32 v2, abs(v20), abs(v21), v2
v_max3_f32 v2, abs(v52), abs(v53), v2
v_pk_add_f32 v[76:77], v[4:5], v[36:37]
v_pk_add_f32 v[92:93], v[4:5], v[36:37] neg_lo:[0,1] neg_hi:[0,1]
v_max3_f32 v3, abs(v76), abs(v77), v3
v_max3_f32 v3, abs(v92), abs(v93), v3
v_pk_add_f32 v[4:5], v[22:23], v[54:55]
v_max3_f32 v2, abs(v22), abs(v23), v2
v_max3_f32 v2, abs(v54), abs(v55), v2
v_pk_add_f32 v[78:79], v[4:5], v[38:39]
v_pk_add_f32 v[94:95], v[4:5], v[38:39] neg_lo:[0,1] neg_hi:[0,1]
v_max3_f32 v3, abs(v78), abs(v79), v3
v_max3_f32 v3, abs(v94), abs(v95), v3
v_pk_add_f32 v[4:5], v[24:25], v[56:57]
v_max3_f32 v2, abs(v24), abs(v25), v2
v_max3_f32 v2, abs(v56), abs(v57), v2
v_pk_add_f32 v[80:81], v[4:5], v[40:41]
v_pk_add_f32 v[96:97], v[4:5], v[40:41] neg_lo:[0,1] neg_hi:[0,1]
v_max3_f32 v3, abs(v80), abs(v81), v3
v_max3_f32 v3, abs(v96), abs(v97), v3
v_pk_add_f32 v[4:5], v[26:27], v[58:59]
v_max3_f32 v2, abs(v26), abs(v27), v2
v_max3_f32 v2, abs(v58), abs(v59), v2
v_pk_add_f32 v[82:83], v[4:5], v[42:43]
v_pk_add_f32 v[98:99], v[4:5], v[42:43] neg_lo:[0,1] neg_hi:[0,1]
v_max3_f32 v3, abs(v82), abs(v83), v3
v_max3_f32 v3, abs(v98), abs(v99), v3
v_pk_add_f32 v[4:5], v[28:29], v[60:61]
v_max3_f32 v2, abs(v28), abs(v29), v2
v_max3_f32 v2, abs(v60), abs(v61), v2
v_pk_add_f32 v[84:85], v[4:5], v[44:45]
v_pk_add_f32 v[100:101], v[4:5], v[44:45] neg_lo:[0,1] neg_hi:[0,1]
v_max3_f32 v3, abs(v84), abs(v85), v3
v_max3_f32 v3, abs(v100), abs(v101), v3
v_pk_add_f32 v[4:5], v[30:31], v[62:63]
v_max3_f32 v2, abs(v30), abs(v31), v2
v_max3_f32 v2, abs(v62), abs(v63), v2
v_pk_add_f32 v[86:87], v[4:5], v[46:47]
v_pk_add_f32 v[102:103], v[4:5], v[46:47] neg_lo:[0,1] neg_hi:[0,1]
v_max3_f32 v3, abs(v86), abs(v87), v3
v_max3_f32 v3, abs(v102), abs(v103), v3
v_mul_f32 v3, 0.5, v3
v_max_f32 v2, v2, v3
s_nop 1
v_max_f32_dpp v2, v2, v2 row_ror:8 row_mask:0xf bank_mask:0xf
s_nop 1
v_max_f32_dpp v2, v2, v2 row_ror:4 row_mask:0xf bank_mask:0xf
s_nop 1
v_max_f32_dpp v2, v2, v2 row_ror:2 row_mask:0xf bank_mask:0xf
s_nop 1
v_max_f32_dpp v2, v2, v2 row_ror:1 row_mask:0xf bank_mask:0xf
v_mov_b32 v3, v2
s_nop 1
v_permlane32_swap_b32 v2, v3
s_nop 0
v_max_f32 v2, v2, v3
v_mov_b32 v3, v2
s_nop 1
v_permlane16_swap_b32 v2, v3
s_nop 0
v_max_f32 v2, v2, v3
s_lshl_b32 s36, s24, 2
s_add_u32 s36, s36, 139264
v_mov_b32 v3, s36
ds_write_b32 v3, v2
v_mov_b32 v3, 139264
s_waitcnt lgkmcnt(0)
s_barrier
ds_read_b128 v[4:7], v3
ds_read_b128 v[8:11], v3 offset:16
s_lshl_b32 s36, s29, 1
s_bfe_u32 s37, s24, 0x10001
s_add_u32 s36, s36, s37
s_lshl_b32 s37, s26, 1
s_lshr_b32 s38, s24, 2
s_add_u32 s37, s37, s38
s_and_b32 s38, s24, 1
s_lshl_b32 s38, s38, 11
s_mul_i32 s39, s36, 786432
s_mul_i32 s40, s37, 12288
s_add_u32 s39, s39, s40
s_lshl_b32 s40, s28, 12
s_add_u32 s39, s39, s40
s_add_u32 s39, s39, s38
s_add_u32 s39, s39, 17825792
s_lshl_b32 s40, s36, 16
s_lshl_b32 s41, s37, 12
s_add_u32 s40, s40, s41
s_add_u32 s40, s40, s38
s_add_u32 s40, s40, 24117248
v_lshlrev_b32 v12, 4, v1
s_waitcnt lgkmcnt(0)
v_max3_f32 v4, v4, v5, v6
v_max3_f32 v4, v4, v7, v8
v_max3_f32 v4, v4, v9, v10
v_max_f32 v4, v4, v11
s_nop 0
v_readfirstlane_b32 s42, v4
s_nop 3
s_lshr_b32 s42, s42, 23
s_sub_u32 s43, 121, s42
s_and_b32 s43, s43, 7
s_sub_u32 s42, 267, s42
s_sub_u32 s42, s42, s43
s_max_u32 s42, s42, 18
s_min_u32 s42, s42, 186
s_lshl_b32 s60, s42, 23
s_mov_b32 s62, 0x00040004
v_mov_b32 v6, 0xbf317218
v_mul_f32 v6, s60, v6
v_mul_f32 v8, 0.5, v6
v_pk_mul_f32 v[4:5], v[16:17], v[6:7] op_sel_hi:[1,0]
v_cvt_pk_f16_f32 v104, v4, v5
v_pk_add_u16 v104, v104, s62
v_and_b32 v104, 0xfff8fff8, v104
v_pk_mul_f32 v[4:5], v[18:19], v[6:7] op_sel_hi:[1,0]
v_cvt_pk_f16_f32 v105, v4, v5
v_pk_add_u16 v105, v105, s62
v_and_b32 v105, 0xfff8fff8, v105
v_pk_mul_f32 v[4:5], v[24:25], v[6:7] op_sel_hi:[1,0]
v_cvt_pk_f16_f32 v106, v4, v5
v_pk_add_u16 v106, v106, s62
v_and_b32 v106, 0xfff8fff8, v106
v_pk_mul_f32 v[4:5], v[26:27], v[6:7] op_sel_hi:[1,0]
v_cvt_pk_f16_f32 v107, v4, v5
v_pk_add_u16 v107, v107, s62
v_and_b32 v107, 0xfff8fff8, v107
s_add_u32 s41, s39, 0
buffer_store_dwordx4 v[104:107], v12, s[20:23], s41 offen offset:0 sc1
v_pk_mul_f32 v[4:5], v[20:21], v[6:7] op_sel_hi:[1,0]
v_cvt_pk_f16_f32 v108, v4, v5
v_pk_add_u16 v108, v108, s62
v_and_b32 v108, 0xfff8fff8, v108
v_pk_mul_f32 v[4:5], v[22:23], v[6:7] op_sel_hi:[1,0]
v_cvt_pk_f16_f32 v109, v4, v5
v_pk_add_u16 v109, v109, s62
v_and_b32 v109, 0xfff8fff8, v109
v_pk_mul_f32 v[4:5], v[28:29], v[6:7] op_sel_hi:[1,0]
v_cvt_pk_f16_f32 v110, v4, v5
v_pk_add_u16 v110, v110, s62
v_and_b32 v110, 0xfff8fff8, v110
v_pk_mul_f32 v[4:5], v[30:31], v[6:7] op_sel_hi:[1,0]
v_cvt_pk_f16_f32 v111, v4, v5
v_pk_add_u16 v111, v111, s62
v_and_b32 v111, 0xfff8fff8, v111
s_add_u32 s41, s39, 0
buffer_store_dwordx4 v[108:111], v12, s[20:23], s41 offen offset:1024 sc1
v_pk_mul_f32 v[4:5], v[72:73], v[8:9] op_sel_hi:[1,0]
v_cvt_pk_f16_f32 v112, v4, v5
v_pk_add_u16 v112, v112, s62
v_and_b32 v112, 0xfff8fff8, v112
v_pk_mul_f32 v[4:5], v[74:75], v[8:9] op_sel_hi:[1,0]
v_cvt_pk_f16_f32 v113, v4, v5
v_pk_add_u16 v113, v113, s62
v_and_b32 v113, 0xfff8fff8, v113
v_pk_mul_f32 v[4:5], v[80:81], v[8:9] op_sel_hi:[1,0]
v_cvt_pk_f16_f32 v114, v4, v5
v_pk_add_u16 v114, v114, s62
v_and_b32 v114, 0xfff8fff8, v114
v_pk_mul_f32 v[4:5], v[82:83], v[8:9] op_sel_hi:[1,0]
v_cvt_pk_f16_f32 v115, v4, v5
v_pk_add_u16 v115, v115, s62
v_and_b32 v115, 0xfff8fff8, v115
s_add_u32 s41, s39, 196608
buffer_store_dwordx4 v[112:115], v12, s[20:23], s41 offen offset:0 sc1
v_pk_mul_f32 v[4:5], v[76:77], v[8:9] op_sel_hi:[1,0]
v_cvt_pk_f16_f32 v116, v4, v5
v_pk_add_u16 v116, v116, s62
v_and_b32 v116, 0xfff8fff8, v116
v_pk_mul_f32 v[4:5], v[78:79], v[8:9] op_sel_hi:[1,0]
v_cvt_pk_f16_f32 v117, v4, v5
v_pk_add_u16 v117, v117, s62
v_and_b32 v117, 0xfff8fff8, v117
v_pk_mul_f32 v[4:5], v[84:85], v[8:9] op_sel_hi:[1,0]
v_cvt_pk_f16_f32 v118, v4, v5
v_pk_add_u16 v118, v118, s62
v_and_b32 v118, 0xfff8fff8, v118
v_pk_mul_f32 v[4:5], v[86:87], v[8:9] op_sel_hi:[1,0]
v_cvt_pk_f16_f32 v119, v4, v5
v_pk_add_u16 v119, v119, s62
v_and_b32 v119, 0xfff8fff8, v119
s_add_u32 s41, s39, 196608
buffer_store_dwordx4 v[116:119], v12, s[20:23], s41 offen offset:1024 sc1
v_pk_mul_f32 v[4:5], v[88:89], v[8:9] op_sel_hi:[1,0]
v_cvt_pk_f16_f32 v104, v4, v5
v_pk_add_u16 v104, v104, s62
v_and_b32 v104, 0xfff8fff8, v104
v_pk_mul_f32 v[4:5], v[90:91], v[8:9] op_sel_hi:[1,0]
v_cvt_pk_f16_f32 v105, v4, v5
v_pk_add_u16 v105, v105, s62
v_and_b32 v105, 0xfff8fff8, v105
v_pk_mul_f32 v[4:5], v[96:97], v[8:9] op_sel_hi:[1,0]
v_cvt_pk_f16_f32 v106, v4, v5
v_pk_add_u16 v106, v106, s62
v_and_b32 v106, 0xfff8fff8, v106
v_pk_mul_f32 v[4:5], v[98:99], v[8:9] op_sel_hi:[1,0]
v_cvt_pk_f16_f32 v107, v4, v5
v_pk_add_u16 v107, v107, s62
v_and_b32 v107, 0xfff8fff8, v107
s_add_u32 s41, s39, 393216
buffer_store_dwordx4 v[104:107], v12, s[20:23], s41 offen offset:0 sc1
v_pk_mul_f32 v[4:5], v[92:93], v[8:9] op_sel_hi:[1,0]
v_cvt_pk_f16_f32 v108, v4, v5
v_pk_add_u16 v108, v108, s62
v_and_b32 v108, 0xfff8fff8, v108
v_pk_mul_f32 v[4:5], v[94:95], v[8:9] op_sel_hi:[1,0]
v_cvt_pk_f16_f32 v109, v4, v5
v_pk_add_u16 v109, v109, s62
v_and_b32 v109, 0xfff8fff8, v109
v_pk_mul_f32 v[4:5], v[100:101], v[8:9] op_sel_hi:[1,0]
v_cvt_pk_f16_f32 v110, v4, v5
v_pk_add_u16 v110, v110, s62
v_and_b32 v110, 0xfff8fff8, v110
v_pk_mul_f32 v[4:5], v[102:103], v[8:9] op_sel_hi:[1,0]
v_cvt_pk_f16_f32 v111, v4, v5
v_pk_add_u16 v111, v111, s62
v_and_b32 v111, 0xfff8fff8, v111
s_add_u32 s41, s39, 393216
buffer_store_dwordx4 v[108:111], v12, s[20:23], s41 offen offset:1024 sc1
v_pk_mul_f32 v[4:5], v[48:49], v[6:7] op_sel_hi:[1,0]
v_cvt_pk_f16_f32 v112, v4, v5
v_pk_add_u16 v112, v112, s62
v_and_b32 v112, 0xfff8fff8, v112
v_pk_mul_f32 v[4:5], v[50:51], v[6:7] op_sel_hi:[1,0]
v_cvt_pk_f16_f32 v113, v4, v5
v_pk_add_u16 v113, v113, s62
v_and_b32 v113, 0xfff8fff8, v113
v_pk_mul_f32 v[4:5], v[56:57], v[6:7] op_sel_hi:[1,0]
v_cvt_pk_f16_f32 v114, v4, v5
v_pk_add_u16 v114, v114, s62
v_and_b32 v114, 0xfff8fff8, v114
v_pk_mul_f32 v[4:5], v[58:59], v[6:7] op_sel_hi:[1,0]
v_cvt_pk_f16_f32 v115, v4, v5
v_pk_add_u16 v115, v115, s62
v_and_b32 v115, 0xfff8fff8, v115
s_add_u32 s41, s39, 589824
buffer_store_dwordx4 v[112:115], v12, s[20:23], s41 offen offset:0 sc1
v_pk_mul_f32 v[4:5], v[52:53], v[6:7] op_sel_hi:[1,0]
v_cvt_pk_f16_f32 v116, v4, v5
v_pk_add_u16 v116, v116, s62
v_and_b32 v116, 0xfff8fff8, v116
v_pk_mul_f32 v[4:5], v[54:55], v[6:7] op_sel_hi:[1,0]
v_cvt_pk_f16_f32 v117, v4, v5
v_pk_add_u16 v117, v117, s62
v_and_b32 v117, 0xfff8fff8, v117
v_pk_mul_f32 v[4:5], v[60:61], v[6:7] op_sel_hi:[1,0]
v_cvt_pk_f16_f32 v118, v4, v5
v_pk_add_u16 v118, v118, s62
v_and_b32 v118, 0xfff8fff8, v118
v_pk_mul_f32 v[4:5], v[62:63], v[6:7] op_sel_hi:[1,0]
v_cvt_pk_f16_f32 v119, v4, v5
v_pk_add_u16 v119, v119, s62
v_and_b32 v119, 0xfff8fff8, v119
s_add_u32 s41, s39, 589824
buffer_store_dwordx4 v[116:119], v12, s[20:23], s41 offen offset:1024 sc1
s_lshl_b32 s41, s29, 5
s_lshl_b32 s42, s28, 3
s_add_u32 s41, s41, s42
s_add_u32 s41, s41, s26
s_lshl_b32 s41, s41, 2
s_add_u32 s41, s41, 0
v_mov_b32 v4, s60
v_mov_b32 v5, 0
s_cmp_lg_u32 s24, 0
s_cbranch_scc1 cn_k1_kernel_ns
s_mov_b64 exec, 1
buffer_store_dword v4, v5, s[20:23], s41 offen
s_mov_b64 exec, -1
cn_k1_kernel_ns:
s_cmp_lg_u32 s28, 1
s_cbranch_scc1 cn_k1_kernel_nz
s_cmp_ge_u32 s26, 4
s_cselect_b32 s61, 0x800000, 0
s_sub_u32 s60, s60, s61
v_lshlrev_b32 v4, 16, v64
v_and_b32 v5, 0xffff0000, v64
v_mul_f32 v4, s60, v4
v_mul_f32 v5, s60, v5
v_cvt_pk_bf16_f32 v64, v4, v5
v_lshlrev_b32 v4, 16, v65
v_and_b32 v5, 0xffff0000, v65
v_mul_f32 v4, s60, v4
v_mul_f32 v5, s60, v5
v_cvt_pk_bf16_f32 v65, v4, v5
v_lshlrev_b32 v4, 16, v66
v_and_b32 v5, 0xffff0000, v66
v_mul_f32 v4, s60, v4
v_mul_f32 v5, s60, v5
v_cvt_pk_bf16_f32 v66, v4, v5
v_lshlrev_b32 v4, 16, v67
v_and_b32 v5, 0xffff0000, v67
v_mul_f32 v4, s60, v4
v_mul_f32 v5, s60, v5
v_cvt_pk_bf16_f32 v67, v4, v5
v_lshlrev_b32 v4, 16, v68
v_and_b32 v5, 0xffff0000, v68
v_mul_f32 v4, s60, v4
v_mul_f32 v5, s60, v5
v_cvt_pk_bf16_f32 v68, v4, v5
v_lshlrev_b32 v4, 16, v69
v_and_b32 v5, 0xffff0000, v69
v_mul_f32 v4, s60, v4
v_mul_f32 v5, s60, v5
v_cvt_pk_bf16_f32 v69, v4, v5
v_lshlrev_b32 v4, 16, v70
v_and_b32 v5, 0xffff0000, v70
v_mul_f32 v4, s60, v4
v_mul_f32 v5, s60, v5
v_cvt_pk_bf16_f32 v70, v4, v5
v_lshlrev_b32 v4, 16, v71
v_and_b32 v5, 0xffff0000, v71
v_mul_f32 v4, s60, v4
v_mul_f32 v5, s60, v5
v_cvt_pk_bf16_f32 v71, v4, v5
buffer_store_dwordx4 v[64:67], v12, s[20:23], s40 offen offset:0 sc1
buffer_store_dwordx4 v[68:71], v12, s[20:23], s40 offen offset:1024 sc1
cn_k1_kernel_nz:
s_endpgm
cn_k1_kernel_pf:
s_load_dwordx4 s[64:67], s[0:1], 16
v_lshlrev_b32 v210, 7, v1
v_and_b32 v211, 3, v1
v_lshrrev_b32 v212, 2, v1
v_lshlrev_b32 v211, 7, v211
v_lshl_add_u32 v211, v212, 10, v211
v_add_u32 v211, 512, v211
v_and_b32 v209, 1, v1
v_lshrrev_b32 v212, 1, v1
v_lshlrev_b32 v209, 7, v209
v_lshl_add_u32 v209, v212, 10, v209
v_add_u32 v209, 256, v209
s_sub_u32 s72, s25, 28
s_lshl_b32 s73, s26, 20
s_waitcnt lgkmcnt(0)
s_mov_b32 s68, s66
s_mov_b32 s69, s67
s_mov_b32 s70, 524288
s_mov_b32 s71, 0x20000
s_mov_b32 s66, 8388608
s_mov_b32 s67, 0x20000
s_sub_u32 s74, s24, 0
s_and_b32 s74, s74, 7
s_mul_i32 s75, s72, 1
s_add_u32 s75, s75, s74
s_lshl_b32 s75, s75, 13
s_add_u32 s75, s75, 98304
s_cmp_ge_u32 s74, 1
s_cbranch_scc1 cn_k1_kernel_p_h0
buffer_load_dword v213, v210, s[68:71], s75 offen
cn_k1_kernel_p_h0:
s_barrier
s_sub_u32 s74, s24, 1
s_and_b32 s74, s74, 7
s_mul_i32 s75, s72, 2
s_add_u32 s75, s75, s74
s_lshl_b32 s75, s75, 15
s_add_u32 s75, s75, 786432
s_add_u32 s75, s75, s73
s_cmp_ge_u32 s74, 2
s_cbranch_scc1 cn_k1_kernel_p_h1
buffer_load_dword v213, v209, s[64:67], s75 offen
cn_k1_kernel_p_h1:
s_waitcnt vmcnt(0)
s_barrier
s_sub_u32 s74, s24, 3
s_and_b32 s74, s74, 7
s_mul_i32 s75, s72, 3
s_add_u32 s75, s75, s74
s_lshl_b32 s75, s75, 13
s_add_u32 s75, s75, 425984
s_cmp_ge_u32 s74, 3
s_cbranch_scc1 cn_k1_kernel_p_h2
buffer_load_dword v213, v210, s[68:71], s75 offen
cn_k1_kernel_p_h2:
s_barrier
s_sub_u32 s74, s24, 6
s_and_b32 s74, s74, 7
s_mul_i32 s75, s72, 4
s_add_u32 s75, s75, s74
s_lshl_b32 s75, s75, 14
s_add_u32 s75, s75, 786432
s_add_u32 s75, s75, s73
s_cmp_ge_u32 s74, 4
s_cbranch_scc1 cn_k1_kernel_p_h3
buffer_load_dword v213, v211, s[64:67], s75 offen
cn_k1_kernel_p_h3:
s_barrier
s_sub_u32 s74, s24, 2
s_and_b32 s74, s74, 7
s_mul_i32 s75, s72, 20
s_add_u32 s75, s75, s74
s_lshl_b32 s75, s75, 13
s_add_u32 s75, s75, 393216
s_add_u32 s75, s75, s73
buffer_load_dword v213, v210, s[12:15], s75 offen
s_add_u32 s75, s75, 65536
buffer_load_dword v214, v210, s[12:15], s75 offen
s_add_u32 s75, s75, 65536
s_cmp_ge_u32 s74, 4
s_cbranch_scc1 cn_k1_kernel_p_h4
buffer_load_dword v213, v210, s[12:15], s75 offen
cn_k1_kernel_p_h4:
s_barrier
s_waitcnt vmcnt(0) lgkmcnt(0)
cn_k1_kernel_end:
s_endpgm
.section .rodata,"a"
.p2align 6
.amdhsa_kernel cn_k1_kernel
  .amdhsa_next_free_vgpr 216
  .amdhsa_next_free_sgpr 100
  .amdhsa_accum_offset 216
  .amdhsa_group_segment_fixed_size 0
  .amdhsa_kernarg_size 72
  .amdhsa_user_sgpr_count 2
  .amdhsa_user_sgpr_kernarg_segment_ptr 1
  .amdhsa_system_sgpr_workgroup_id_x 1
.end_amdhsa_kernel
.text
.globl cn_k2_kernel
.p2align 8
.type cn_k2_kernel,@function
cn_k2_kernel:
s_cmp_ge_u32 s2, 256
s_cbranch_scc1 cn_k2_kernel_end
s_load_dwordx2 s[12:13], s[0:1], 0
s_load_dwordx2 s[16:17], s[0:1], 48
s_load_dwordx2 s[8:9], s[0:1], 64
s_getpc_b64 s[68:69]
cn_k2_kernel_pc:
s_lshr_b32 s70, s2, 3
s_mul_i32 s70, s70, 384
v_lshl_add_u32 v238, v0, 7, s70
v_min_u32 v238, cn_k2_kernel_end-cn_k2_kernel_pc, v238
v_cmp_gt_u32 vcc, 3, v0
s_and_saveexec_b64 s[70:71], vcc
s_cbranch_execz cn_k2_kernel_nic
global_load_dword v168, v238, s[68:69]
cn_k2_kernel_nic:
s_mov_b64 exec, s[70:71]
v_lshrrev_b32 v238, 6, v0
s_and_b32 s64, s2, 7
v_readfirstlane_b32 s36, v238
s_lshr_b32 s65, s2, 3
s_and_b32 s37, s64, 1
s_lshl_b32 s37, s37, 2
s_and_b32 s66, s65, 3
s_or_b32 s37, s37, s66
s_bfe_u32 s38, s65, 0x10002
s_lshr_b32 s66, s65, 3
s_lshr_b32 s67, s64, 1
s_lshl_b32 s67, s67, 2
s_add_u32 s67, s67, s66
s_lshl_b32 s39, s67, 3
v_and_b32 v239, 63, v0
v_lshlrev_b32 v1, 4, v239
s_mul_i32 s68, s36, 340
s_lshl_b32 s72, s39, 12
s_lshl_b32 s69, s38, 10
s_add_u32 s72, s72, s69
s_lshl_b32 s69, s38, 2
s_sub_u32 s69, 68, s69
s_and_b32 s70, s39, 63
s_cmp_eq_u32 s70, 0
s_cselect_b32 s73, 136, 0
s_cmp_eq_u32 s70, 56
s_movk_i32 s70, 1400
s_cselect_b32 s70, 1224, s70
s_sub_u32 s70, s70, s73
s_movk_i32 s71, 964
s_movk_i32 s76, 896
s_movk_i32 s77, -136
v_add_u32 v240, s68, v239
v_mov_b32 v246, 0x40000000
v_mul_u32_u24 v241, s71, v240
v_lshl_add_u32 v243, v240, 4, s72
v_lshrrev_b32 v242, 17, v241
v_lshrrev_b32 v241, 16, v241
v_subrev_u32 v245, s73, v240
v_mad_i32_i24 v244, v242, s77, v240
v_cmp_gt_u32 s[74:75], s70, v245
v_subrev_u32 v244, s69, v244
v_mad_u32_u24 v243, v241, s76, v243
v_cmp_le_u32 vcc, 4, v244
v_lshl_add_u32 v243, v242, 7, v243
s_and_b64 vcc, vcc, s[74:75]
v_cndmask_b32 v8, v246, v243, vcc
v_add_u32 v240, 64, v240
v_mul_u32_u24 v241, s71, v240
v_lshl_add_u32 v243, v240, 4, s72
v_lshrrev_b32 v242, 17, v241
v_lshrrev_b32 v241, 16, v241
v_subrev_u32 v245, s73, v240
v_mad_i32_i24 v244, v242, s77, v240
v_cmp_gt_u32 s[74:75], s70, v245
v_subrev_u32 v244, s69, v244
v_mad_u32_u24 v243, v241, s76, v243
v_cmp_le_u32 vcc, 4, v244
v_lshl_add_u32 v243, v242, 7, v243
s_and_b64 vcc, vcc, s[74:75]
v_subrev_u32 v243, 1024, v243
v_cndmask_b32 v9, v246, v243, vcc
v_add_u32 v240, 64, v240
v_mul_u32_u24 v241, s71, v240
v_lshl_add_u32 v243, v240, 4, s72
v_lshrrev_b32 v242, 17, v241
v_lshrrev_b32 v241, 16, v241
v_subrev_u32 v245, s73, v240
v_mad_i32_i24 v244, v242, s77, v240
v_cmp_gt_u32 s[74:75], s70, v245
v_subrev_u32 v244, s69, v244
v_mad_u32_u24 v243, v241, s76, v243
v_cmp_le_u32 vcc, 4, v244
v_lshl_add_u32 v243, v242, 7, v243
s_and_b64 vcc, vcc, s[74:75]
v_subrev_u32 v243, 2048, v243
v_cndmask_b32 v10, v246, v243, vcc
v_add_u32 v240, 64, v240
v_mul_u32_u24 v241, s71, v240
v_lshl_add_u32 v243, v240, 4, s72
v_lshrrev_b32 v242, 17, v241
v_lshrrev_b32 v241, 16, v241
v_subrev_u32 v245, s73, v240
v_mad_i32_i24 v244, v242, s77, v240
v_cmp_gt_u32 s[74:75], s70, v245
v_subrev_u32 v244, s69, v244
v_mad_u32_u24 v243, v241, s76, v243
v_cmp_le_u32 vcc, 4, v244
v_lshl_add_u32 v243, v242, 7, v243
s_and_b64 vcc, vcc, s[74:75]
v_subrev_u32 v243, 3072, v243
v_cndmask_b32 v11, v246, v243, vcc
v_add_u32 v240, 64, v240
v_mul_u32_u24 v241, s71, v240
v_lshl_add_u32 v243, v240, 4, s72
v_lshrrev_b32 v242, 17, v241
v_lshrrev_b32 v241, 16, v241
v_subrev_u32 v245, s73, v240
v_mad_i32_i24 v244, v242, s77, v240
v_cmp_gt_u32 s[74:75], s70, v245
v_subrev_u32 v244, s69, v244
v_mad_u32_u24 v243, v241, s76, v243
v_cmp_le_u32 vcc, 4, v244
v_lshl_add_u32 v243, v242, 7, v243
s_and_b64 vcc, vcc, s[74:75]
v_cndmask_b32 v12, v246, v243, vcc
v_add_u32 v240, 64, v240
v_mul_u32_u24 v241, s71, v240
v_lshl_add_u32 v243, v240, 4, s72
v_lshrrev_b32 v242, 17, v241
v_lshrrev_b32 v241, 16, v241
v_subrev_u32 v245, s73, v240
v_mad_i32_i24 v244, v242, s77, v240
v_cmp_gt_u32 s[74:75], s70, v245
v_subrev_u32 v244, s69, v244
v_mad_u32_u24 v243, v241, s76, v243
v_cmp_le_u32 vcc, 4, v244
v_lshl_add_u32 v243, v242, 7, v243
s_and_b64 vcc, vcc, s[74:75]
v_subrev_u32 v243, 1024, v243
v_cndmask_b32 v13, v246, v243, vcc
v_add_u32 v2, 4096, v1
v_add_u32 v3, 8192, v1
v_add_u32 v4, 12288, v1
v_add_u32 v5, 16384, v1
v_add_u32 v6, 20480, v1
s_lshl_b32 s68, s37, 2
s_add_u32 s68, s68, s36
s_mul_i32 s20, s68, 196608
s_add_u32 s20, s20, 17825792
s_lshl_b32 s68, s67, 1
s_add_u32 s68, s68, s38
s_lshl_b32 s68, s68, 2
s_add_u32 s68, s68, s36
s_lshl_b32 s21, s68, 16
s_add_u32 s21, s21, 9437184
s_add_u32 s68, s36, 1
s_bfe_u32 s68, s68, 0x10001
s_lshl_b32 s68, s68, 15
s_lshl_b32 s22, s37, 16
s_add_u32 s22, s22, s68
s_add_u32 s22, s22, 24117248
s_mul_i32 s25, s36, 5440
s_add_u32 s25, s25, 0x10000
s_mov_b32 s30, 0xfffff
s_mov_b32 s31, 0
s_mov_b64 s[80:81], 0
s_waitcnt lgkmcnt(0)
s_add_u32 s4, s8, 1044480
s_addc_u32 s5, s9, 0
s_mov_b32 s6, 8392704
s_mov_b32 s7, 0x20000
s_mov_b32 s10, 0x10000000
s_mov_b32 s11, 0x20000
s_mov_b32 s14, 8388608
s_mov_b32 s15, 0x20000
s_mov_b32 s18, 8388608
s_mov_b32 s19, 0x20000
s_lshr_b32 s40, s37, 1
s_lshl_b32 s40, s40, 7
s_add_u32 s40, s40, 0
v_min_u32 v254, 23, v239
v_lshlrev_b32 v254, 2, v254
cn_k2_kernel_reload:
s_mov_b32 s23, 0
s_add_u32 m0, s25, 0
s_nop 0
buffer_load_dwordx4 v8, s[4:7], s23 offen offset:0 lds
buffer_load_dwordx4 v9, s[4:7], s23 offen offset:1024 lds
buffer_load_dwordx4 v10, s[4:7], s23 offen offset:2048 lds
buffer_load_dwordx4 v11, s[4:7], s23 offen offset:3072 lds
s_add_u32 m0, s25, 4096
s_nop 0
buffer_load_dwordx4 v12, s[4:7], s23 offen offset:0 lds
s_mov_b64 exec, s[30:31]
buffer_load_dwordx4 v13, s[4:7], s23 offen offset:1024 lds
s_mov_b64 exec, -1
buffer_load_dword v255, v254, s[8:11], s40 offen
s_mov_b32 s23, 524288
s_mov_b32 s24, 1048576
buffer_load_dwordx4 v[120:123], v1, s[8:11], s22 offen offset:0
buffer_load_dwordx4 a[224:227], v1, s[8:11], s21 offen offset:0
buffer_load_dwordx4 a[228:231], v1, s[8:11], s21 offen offset:1024
buffer_load_dwordx4 a[232:235], v1, s[8:11], s21 offen offset:2048
v_and_b32 v238, 15, v0
v_bfe_u32 v239, v0, 4, 2
s_and_b32 s64, s36, 1
s_xor_b32 s64, s64, 1
s_cmp_eq_u32 s36, 2
s_cselect_b32 s65, 1, 0
s_cselect_b32 s67, 0, 1
s_cmp_lt_u32 s36, 2
s_cselect_b32 s66, 1, 0
s_cmp_eq_u32 s36, 1
s_mov_b32 s27, 0xbc00bc00
s_cselect_b32 s27, 0x3c003c00, s27
v_add_u32 v240, s65, v238
v_subrev_u32 v241, s64, v240
v_lshrrev_b32 v241, 1, v241
v_and_b32 v241, 2, v241
v_xor_b32 v241, v241, v239
v_lshlrev_b32 v240, 6, v240
v_lshl_add_u32 v240, v241, 4, v240
s_mul_i32 s68, s64, 1088
s_add_u32 s68, s68, 0x10000
v_add_u32 v14, s68, v240
v_add_u32 v240, s67, v238
v_subrev_u32 v241, s66, v240
v_lshrrev_b32 v241, 1, v241
v_and_b32 v241, 2, v241
v_xor_b32 v241, v241, v239
v_lshlrev_b32 v240, 6, v240
v_lshl_add_u32 v240, v241, 4, v240
s_mul_i32 s68, s66, 1088
s_add_u32 s68, s68, 0x10000
v_add_u32 v15, s68, v240
s_lshl_b32 s68, s36, 12
v_and_b32 v240, 7, v238
v_xor_b32 v240, v240, v239
v_lshlrev_b32 v241, 8, v238
v_add_u32 v241, s68, v241
v_lshl_add_u32 v233, v240, 4, v241
v_xor_b32 v234, 64, v233
v_add_u32 v235, 0x10000, v233
v_add_u32 v236, 0x10000, v234
v_bfe_u32 v240, v0, 3, 3
v_and_b32 v241, 7, v0
v_lshlrev_b32 v242, 1, v241
v_xor_b32 v242, v242, v240
s_lshr_b32 s70, s36, 1
s_and_b32 s71, s36, 1
s_lshl_b32 s68, s70, 14
s_lshl_b32 s69, s71, 11
s_add_u32 s68, s68, s69
v_lshlrev_b32 v243, 8, v240
v_add_u32 v243, s68, v243
v_lshl_add_u32 v250, v242, 4, v243
v_xor_b32 v251, 16, v250
v_add_u32 v252, 0x10000, v250
v_add_u32 v253, 0x10000, v251
v_lshlrev_b32 v232, 11, v240
v_lshl_add_u32 v232, v241, 4, v232
s_add_u32 s68, s70, s39
s_lshl_b32 s68, s68, 16
s_lshl_b32 s69, s38, 15
s_add_u32 s68, s68, s69
s_lshl_b32 s69, s71, 14
s_add_u32 s68, s68, s69
s_lshl_b32 s69, s37, 7
s_add_u32 s32, s68, s69
s_add_u32 s33, s32, 131072
s_add_u32 s34, s32, 262144
s_add_u32 s35, s32, 393216
v_and_b32 v240, 15, v0
v_bfe_u32 v241, v0, 4, 2
v_lshlrev_b32 v136, 10, v240
v_lshl_add_u32 v136, v241, 17, v136
s_mov_b32 s26, 6
s_waitcnt vmcnt(4)
s_barrier
v_readfirstlane_b32 s64, v255
s_nop 1
v_cmp_ne_u32 vcc, s64, v255
s_sub_u32 s28, 0x7f000000, s64
s_mov_b32 s29, s28
s_xor_b32 s82, s28, 0x80000000
s_andn2_b64 vcc, vcc, s[80:81]
s_cbranch_scc1 cn_k2_kernel_fix
ds_read_b128 v[96:99], v14 offset:0
ds_read_b128 v[100:103], v15 offset:0
ds_read_b128 v[104:107], v14 offset:2176
ds_read_b128 v[108:111], v15 offset:2176
ds_read_b128 v[112:115], v14 offset:4352
ds_read_b128 v[116:119], v15 offset:4352
buffer_load_dwordx4 a[236:239], v1, s[8:11], s21 offen offset:3072
buffer_load_dwordx4 a[240:243], v2, s[8:11], s21 offen offset:0
s_waitcnt lgkmcnt(4)
v_pk_fma_f16 v16, v100, s27, v96
v_pk_fma_f16 v17, v101, s27, v97
v_pk_fma_f16 v18, v102, s27, v98
v_pk_fma_f16 v19, v103, s27, v99
ds_read_b128 v[96:99], v14 offset:6528
ds_read_b128 v[100:103], v15 offset:6528
buffer_load_dwordx4 a[244:247], v2, s[8:11], s21 offen offset:1024
buffer_load_dwordx4 a[248:251], v2, s[8:11], s21 offen offset:2048
buffer_load_dwordx4 a[252:255], v2, s[8:11], s21 offen offset:3072
s_add_u32 s21, s21, 8192
s_waitcnt lgkmcnt(4)
v_pk_fma_f16 v20, v108, s27, v104
v_pk_fma_f16 v21, v109, s27, v105
v_pk_fma_f16 v22, v110, s27, v106
v_pk_fma_f16 v23, v111, s27, v107
ds_read_b128 v[104:107], v14 offset:8704
ds_read_b128 v[108:111], v15 offset:8704
buffer_load_dwordx4 v[124:127], v1, s[8:11], s22 offen offset:1024
buffer_load_dwordx4 v[128:131], v1, s[8:11], s22 offen offset:2048
buffer_load_dwordx4 v[132:135], v1, s[8:11], s22 offen offset:3072
s_add_u32 s22, s22, 4096
s_waitcnt lgkmcnt(4)
v_pk_fma_f16 v24, v116, s27, v112
v_pk_fma_f16 v25, v117, s27, v113
v_pk_fma_f16 v26, v118, s27, v114
v_pk_fma_f16 v27, v119, s27, v115
ds_read_b128 v[112:115], v14 offset:10880
ds_read_b128 v[116:119], v15 offset:10880
s_waitcnt vmcnt(3)
v_mfma_f32_16x16x32_bf16 a[0:3], v[120:123], a[224:227], 0
s_waitcnt lgkmcnt(4)
v_pk_fma_f16 v28, v100, s27, v96
v_mfma_f32_16x16x32_bf16 a[16:19], v[120:123], a[228:231], 0
buffer_load_dwordx4 a[128:131], v1, s[8:11], s20 offen offset:0
v_pk_fma_f16 v29, v101, s27, v97
v_mfma_f32_16x16x32_bf16 a[32:35], v[120:123], a[232:235], 0
buffer_load_dwordx4 a[144:147], v2, s[8:11], s20 offen offset:0
v_pk_fma_f16 v30, v102, s27, v98
v_mfma_f32_16x16x32_bf16 a[48:51], v[120:123], a[236:239], 0
buffer_load_dwordx4 a[160:163], v3, s[8:11], s20 offen offset:0
v_pk_fma_f16 v31, v103, s27, v99
v_mfma_f32_16x16x32_bf16 a[64:67], v[120:123], a[240:243], 0
s_waitcnt lgkmcnt(2)
v_pk_fma_f16 v32, v108, s27, v104
v_mfma_f32_16x16x32_bf16 a[80:83], v[120:123], a[244:247], 0
ds_read_b128 v[96:99], v14 offset:13056
s_xor_b32 s25, s25, 0x10000
v_pk_fma_f16 v33, v109, s27, v105
s_add_u32 m0, s25, 0
v_mfma_f32_16x16x32_bf16 a[96:99], v[120:123], a[248:251], 0
ds_read_b128 v[100:103], v15 offset:13056
buffer_load_dwordx4 v8, s[4:7], s23 offen offset:0 lds
v_pk_fma_f16 v34, v110, s27, v106
buffer_load_dwordx4 v9, s[4:7], s23 offen offset:1024 lds
v_mfma_f32_16x16x32_bf16 a[112:115], v[120:123], a[252:255], 0
v_pk_fma_f16 v35, v111, s27, v107
s_waitcnt vmcnt(7)
v_mfma_f32_16x16x32_bf16 a[4:7], v[124:127], a[224:227], 0
buffer_load_dwordx4 v10, s[4:7], s23 offen offset:2048 lds
s_waitcnt lgkmcnt(2)
v_pk_fma_f16 v36, v116, s27, v112
ds_read_b128 v[104:107], v14 offset:15232
v_mfma_f32_16x16x32_bf16 a[20:23], v[124:127], a[228:231], 0
v_pk_fma_f16 v37, v117, s27, v113
ds_read_b128 v[108:111], v15 offset:15232
buffer_load_dwordx4 v11, s[4:7], s23 offen offset:3072 lds
v_mfma_f32_16x16x32_bf16 a[36:39], v[124:127], a[232:235], 0
v_pk_fma_f16 v38, v118, s27, v114
s_add_u32 m0, s25, 4096
v_mfma_f32_16x16x32_bf16 a[52:55], v[124:127], a[236:239], 0
v_pk_fma_f16 v39, v119, s27, v115
buffer_load_dwordx4 v12, s[4:7], s23 offen offset:0 lds
v_mfma_f32_16x16x32_bf16 a[68:71], v[124:127], a[240:243], 0
s_waitcnt lgkmcnt(2)
v_pk_fma_f16 v40, v100, s27, v96
ds_read_b128 v[112:115], v14 offset:17408
s_mov_b64 exec, s[30:31]
buffer_load_dwordx4 v13, s[4:7], s23 offen offset:1024 lds
s_mov_b64 exec, -1
v_mfma_f32_16x16x32_bf16 a[84:87], v[124:127], a[244:247], 0
s_add_u32 s23, s23, 1048576
v_pk_fma_f16 v41, v101, s27, v97
ds_read_b128 v[116:119], v15 offset:17408
v_mfma_f32_16x16x32_bf16 a[100:103], v[124:127], a[248:251], 0
v_pk_fma_f16 v42, v102, s27, v98
buffer_load_dwordx4 a[132:135], v1, s[8:11], s20 offen offset:1024
v_mfma_f32_16x16x32_bf16 a[116:119], v[124:127], a[252:255], 0
v_pk_fma_f16 v43, v103, s27, v99
buffer_load_dwordx4 a[148:151], v2, s[8:11], s20 offen offset:1024
s_waitcnt lgkmcnt(2)
v_pk_fma_f16 v44, v108, s27, v104
s_waitcnt vmcnt(12)
v_mfma_f32_16x16x32_bf16 a[8:11], v[128:131], a[224:227], 0
ds_read_b128 v[96:99], v14 offset:19584
v_pk_fma_f16 v45, v109, s27, v105
v_mfma_f32_16x16x32_bf16 a[24:27], v[128:131], a[228:231], 0
ds_read_b128 v[100:103], v15 offset:19584
buffer_load_dwordx4 a[164:167], v3, s[8:11], s20 offen offset:1024
v_pk_fma_f16 v46, v110, s27, v106
v_mfma_f32_16x16x32_bf16 a[40:43], v[128:131], a[232:235], 0
buffer_load_dwordx4 a[136:139], v1, s[8:11], s20 offen offset:2048
v_pk_fma_f16 v47, v111, s27, v107
v_mfma_f32_16x16x32_bf16 a[56:59], v[128:131], a[236:239], 0
s_waitcnt lgkmcnt(2)
v_pk_fma_f16 v48, v116, s27, v112
v_mfma_f32_16x16x32_bf16 a[72:75], v[128:131], a[240:243], 0
buffer_load_dwordx4 a[152:155], v2, s[8:11], s20 offen offset:2048
v_pk_fma_f16 v49, v117, s27, v113
v_mfma_f32_16x16x32_bf16 a[88:91], v[128:131], a[244:247], 0
v_pk_fma_f16 v50, v118, s27, v114
buffer_load_dwordx4 a[168:171], v3, s[8:11], s20 offen offset:2048
v_mfma_f32_16x16x32_bf16 a[104:107], v[128:131], a[248:251], 0
v_pk_fma_f16 v51, v119, s27, v115
buffer_load_dwordx4 a[140:143], v1, s[8:11], s20 offen offset:3072
v_mfma_f32_16x16x32_bf16 a[120:123], v[128:131], a[252:255], 0
s_waitcnt lgkmcnt(0)
v_pk_fma_f16 v52, v100, s27, v96
s_waitcnt vmcnt(16)
v_mfma_f32_16x16x32_bf16 a[12:15], v[132:135], a[224:227], 0
v_pk_fma_f16 v53, v101, s27, v97
buffer_load_dwordx4 a[156:159], v2, s[8:11], s20 offen offset:3072
v_mfma_f32_16x16x32_bf16 a[28:31], v[132:135], a[228:231], 0
v_pk_fma_f16 v54, v102, s27, v98
buffer_load_dwordx4 a[172:175], v3, s[8:11], s20 offen offset:3072
v_mfma_f32_16x16x32_bf16 a[44:47], v[132:135], a[232:235], 0
v_pk_fma_f16 v55, v103, s27, v99
s_add_u32 m0, s25, 21760
v_mfma_f32_16x16x32_bf16 a[60:63], v[132:135], a[236:239], 0
buffer_load_dwordx4 v8, s[4:7], s24 offen offset:0 lds
v_mfma_f32_16x16x32_bf16 a[76:79], v[132:135], a[240:243], 0
buffer_load_dwordx4 v9, s[4:7], s24 offen offset:1024 lds
v_mfma_f32_16x16x32_bf16 a[92:95], v[132:135], a[244:247], 0
buffer_load_dwordx4 v10, s[4:7], s24 offen offset:2048 lds
v_mfma_f32_16x16x32_bf16 a[108:111], v[132:135], a[248:251], 0
v_mfma_f32_16x16x32_bf16 a[124:127], v[132:135], a[252:255], 0
v_xor_b32 v14, 0x10000, v14
v_xor_b32 v15, 0x10000, v15
.p2align 6
cn_k2_kernel_loop:
s_waitcnt vmcnt(18)
v_mfma_f32_16x16x32_f16 a[0:3], a[128:131], v[16:19], a[0:3]
buffer_load_dwordx4 v11, s[4:7], s24 offen offset:3072 lds
v_mfma_f32_16x16x32_f16 a[0:3], a[144:147], v[20:23], a[0:3]
v_mfma_f32_16x16x32_f16 a[0:3], a[160:163], v[24:27], a[0:3]
v_mfma_f32_16x16x32_f16 a[16:19], a[160:163], v[28:31], a[16:19]
v_mfma_f32_16x16x32_f16 a[16:19], a[144:147], v[24:27], a[16:19]
s_add_u32 m0, s25, 25856
v_mfma_f32_16x16x32_f16 a[16:19], a[128:131], v[20:23], a[16:19]
buffer_load_dwordx4 v12, s[4:7], s24 offen offset:0 lds
v_mfma_f32_16x16x32_f16 a[32:35], a[128:131], v[24:27], a[32:35]
v_mfma_f32_16x16x32_f16 a[32:35], a[144:147], v[28:31], a[32:35]
s_waitcnt vmcnt(14)
s_barrier
v_mfma_f32_16x16x32_f16 a[32:35], a[160:163], v[32:35], a[32:35]
ds_read_b128 v[96:99], v14 offset:0
v_mfma_f32_16x16x32_f16 a[48:51], a[160:163], v[36:39], a[48:51]
ds_read_b128 v[100:103], v15 offset:0
v_mfma_f32_16x16x32_f16 a[48:51], a[144:147], v[32:35], a[48:51]
s_mov_b64 exec, s[30:31]
buffer_load_dwordx4 v13, s[4:7], s24 offen offset:1024 lds
s_mov_b64 exec, -1
v_mfma_f32_16x16x32_f16 a[48:51], a[128:131], v[28:31], a[48:51]
s_add_u32 s24, s24, 1048576
v_mfma_f32_16x16x32_f16 a[64:67], a[128:131], v[32:35], a[64:67]
v_mfma_f32_16x16x32_f16 a[64:67], a[144:147], v[36:39], a[64:67]
v_mfma_f32_16x16x32_f16 a[64:67], a[160:163], v[40:43], a[64:67]
buffer_load_dwordx4 a[176:179], v4, s[8:11], s20 offen offset:0
v_mfma_f32_16x16x32_f16 a[80:83], a[160:163], v[44:47], a[80:83]
ds_read_b128 v[104:107], v14 offset:2176
v_mfma_f32_16x16x32_f16 a[80:83], a[144:147], v[40:43], a[80:83]
ds_read_b128 v[108:111], v15 offset:2176
v_mfma_f32_16x16x32_f16 a[80:83], a[128:131], v[36:39], a[80:83]
s_waitcnt lgkmcnt(2)
v_pk_fma_f16 v56, v100, s27, v96
v_mfma_f32_16x16x32_f16 a[96:99], a[128:131], v[40:43], a[96:99]
v_pk_fma_f16 v57, v101, s27, v97
v_mfma_f32_16x16x32_f16 a[96:99], a[144:147], v[44:47], a[96:99]
buffer_load_dwordx4 a[192:195], v5, s[8:11], s20 offen offset:0
v_mfma_f32_16x16x32_f16 a[96:99], a[160:163], v[48:51], a[96:99]
v_pk_fma_f16 v58, v102, s27, v98
v_mfma_f32_16x16x32_f16 a[112:115], a[160:163], v[52:55], a[112:115]
v_pk_fma_f16 v59, v103, s27, v99
v_mfma_f32_16x16x32_f16 a[112:115], a[144:147], v[48:51], a[112:115]
v_mfma_f32_16x16x32_f16 a[112:115], a[128:131], v[44:47], a[112:115]
s_waitcnt vmcnt(14)
v_mfma_f32_16x16x32_f16 a[4:7], a[132:135], v[16:19], a[4:7]
ds_read_b128 v[112:115], v14 offset:4352
v_mfma_f32_16x16x32_f16 a[4:7], a[148:151], v[20:23], a[4:7]
buffer_load_dwordx4 a[208:211], v6, s[8:11], s20 offen offset:0
v_mfma_f32_16x16x32_f16 a[4:7], a[164:167], v[24:27], a[4:7]
ds_read_b128 v[116:119], v15 offset:4352
v_mfma_f32_16x16x32_f16 a[20:23], a[164:167], v[28:31], a[20:23]
s_waitcnt lgkmcnt(2)
v_pk_fma_f16 v60, v108, s27, v104
v_mfma_f32_16x16x32_f16 a[20:23], a[148:151], v[24:27], a[20:23]
v_pk_fma_f16 v61, v109, s27, v105
v_mfma_f32_16x16x32_f16 a[20:23], a[132:135], v[20:23], a[20:23]
v_pk_fma_f16 v62, v110, s27, v106
v_mfma_f32_16x16x32_f16 a[36:39], a[132:135], v[24:27], a[36:39]
v_pk_fma_f16 v63, v111, s27, v107
v_mfma_f32_16x16x32_f16 a[36:39], a[148:151], v[28:31], a[36:39]
buffer_load_dwordx4 v[120:123], v1, s[8:11], s22 offen offset:0
v_mfma_f32_16x16x32_f16 a[36:39], a[164:167], v[32:35], a[36:39]
ds_read_b128 v[96:99], v14 offset:6528
v_mfma_f32_16x16x32_f16 a[52:55], a[164:167], v[36:39], a[52:55]
ds_read_b128 v[100:103], v15 offset:6528
v_mfma_f32_16x16x32_f16 a[52:55], a[148:151], v[32:35], a[52:55]
s_waitcnt lgkmcnt(2)
v_pk_fma_f16 v64, v116, s27, v112
v_mfma_f32_16x16x32_f16 a[52:55], a[132:135], v[28:31], a[52:55]
buffer_load_dwordx4 a[224:227], v1, s[8:11], s21 offen offset:0
v_mfma_f32_16x16x32_f16 a[68:71], a[132:135], v[32:35], a[68:71]
v_pk_fma_f16 v65, v117, s27, v113
v_mfma_f32_16x16x32_f16 a[68:71], a[148:151], v[36:39], a[68:71]
v_pk_fma_f16 v66, v118, s27, v114
v_mfma_f32_16x16x32_f16 a[68:71], a[164:167], v[40:43], a[68:71]
v_pk_fma_f16 v67, v119, s27, v115
v_mfma_f32_16x16x32_f16 a[84:87], a[164:167], v[44:47], a[84:87]
buffer_load_dwordx4 a[228:231], v1, s[8:11], s21 offen offset:1024
v_mfma_f32_16x16x32_f16 a[84:87], a[148:151], v[40:43], a[84:87]
ds_read_b128 v[104:107], v14 offset:8704
v_mfma_f32_16x16x32_f16 a[84:87], a[132:135], v[36:39], a[84:87]
ds_read_b128 v[108:111], v15 offset:8704
v_mfma_f32_16x16x32_f16 a[100:103], a[132:135], v[40:43], a[100:103]
s_waitcnt lgkmcnt(2)
v_pk_fma_f16 v68, v100, s27, v96
v_mfma_f32_16x16x32_f16 a[100:103], a[148:151], v[44:47], a[100:103]
v_pk_fma_f16 v69, v101, s27, v97
v_mfma_f32_16x16x32_f16 a[100:103], a[164:167], v[48:51], a[100:103]
v_pk_fma_f16 v70, v102, s27, v98
v_mfma_f32_16x16x32_f16 a[116:119], a[164:167], v[52:55], a[116:119]
buffer_load_dwordx4 a[232:235], v1, s[8:11], s21 offen offset:2048
v_pk_fma_f16 v71, v103, s27, v99
v_mfma_f32_16x16x32_f16 a[116:119], a[148:151], v[48:51], a[116:119]
ds_read_b128 v[112:115], v14 offset:10880
v_mfma_f32_16x16x32_f16 a[116:119], a[132:135], v[44:47], a[116:119]
s_waitcnt vmcnt(16)
v_mfma_f32_16x16x32_f16 a[8:11], a[136:139], v[16:19], a[8:11]
buffer_load_dwordx4 a[236:239], v1, s[8:11], s21 offen offset:3072
v_mfma_f32_16x16x32_f16 a[8:11], a[152:155], v[20:23], a[8:11]
ds_read_b128 v[116:119], v15 offset:10880
v_mfma_f32_16x16x32_f16 a[8:11], a[168:171], v[24:27], a[8:11]
s_waitcnt lgkmcnt(2)
v_pk_fma_f16 v72, v108, s27, v104
v_mfma_f32_16x16x32_f16 a[24:27], a[168:171], v[28:31], a[24:27]
v_pk_fma_f16 v73, v109, s27, v105
v_mfma_f32_16x16x32_f16 a[24:27], a[152:155], v[24:27], a[24:27]
v_pk_fma_f16 v74, v110, s27, v106
v_mfma_f32_16x16x32_f16 a[24:27], a[136:139], v[20:23], a[24:27]
v_pk_fma_f16 v75, v111, s27, v107
v_mfma_f32_16x16x32_f16 a[40:43], a[136:139], v[24:27], a[40:43]
buffer_load_dwordx4 a[240:243], v2, s[8:11], s21 offen offset:0
v_mfma_f32_16x16x32_f16 a[40:43], a[152:155], v[28:31], a[40:43]
ds_read_b128 v[96:99], v14 offset:13056
v_mfma_f32_16x16x32_f16 a[40:43], a[168:171], v[32:35], a[40:43]
ds_read_b128 v[100:103], v15 offset:13056
v_mfma_f32_16x16x32_f16 a[56:59], a[168:171], v[36:39], a[56:59]
s_waitcnt lgkmcnt(2)
v_pk_fma_f16 v76, v116, s27, v112
v_mfma_f32_16x16x32_f16 a[56:59], a[152:155], v[32:35], a[56:59]
v_pk_fma_f16 v77, v117, s27, v113
v_mfma_f32_16x16x32_f16 a[56:59], a[136:139], v[28:31], a[56:59]
buffer_load_dwordx4 a[244:247], v2, s[8:11], s21 offen offset:1024
v_mfma_f32_16x16x32_f16 a[72:75], a[136:139], v[32:35], a[72:75]
v_pk_fma_f16 v78, v118, s27, v114
v_mfma_f32_16x16x32_f16 a[72:75], a[152:155], v[36:39], a[72:75]
v_pk_fma_f16 v79, v119, s27, v115
v_mfma_f32_16x16x32_f16 a[72:75], a[168:171], v[40:43], a[72:75]
buffer_load_dwordx4 a[248:251], v2, s[8:11], s21 offen offset:2048
v_mfma_f32_16x16x32_f16 a[88:91], a[168:171], v[44:47], a[88:91]
ds_read_b128 v[104:107], v14 offset:15232
v_mfma_f32_16x16x32_f16 a[88:91], a[152:155], v[40:43], a[88:91]
ds_read_b128 v[108:111], v15 offset:15232
v_mfma_f32_16x16x32_f16 a[88:91], a[136:139], v[36:39], a[88:91]
s_waitcnt lgkmcnt(2)
v_pk_fma_f16 v80, v100, s27, v96
v_mfma_f32_16x16x32_f16 a[104:107], a[136:139], v[40:43], a[104:107]
v_pk_fma_f16 v81, v101, s27, v97
v_mfma_f32_16x16x32_f16 a[104:107], a[152:155], v[44:47], a[104:107]
v_pk_fma_f16 v82, v102, s27, v98
v_mfma_f32_16x16x32_f16 a[104:107], a[168:171], v[48:51], a[104:107]
buffer_load_dwordx4 a[252:255], v2, s[8:11], s21 offen offset:3072
v_pk_fma_f16 v83, v103, s27, v99
v_mfma_f32_16x16x32_f16 a[120:123], a[168:171], v[52:55], a[120:123]
s_add_u32 s21, s21, 8192
v_mfma_f32_16x16x32_f16 a[120:123], a[152:155], v[48:51], a[120:123]
ds_read_b128 v[112:115], v14 offset:17408
v_mfma_f32_16x16x32_f16 a[120:123], a[136:139], v[44:47], a[120:123]
s_waitcnt vmcnt(18)
v_mfma_f32_16x16x32_f16 a[12:15], a[140:143], v[16:19], a[12:15]
ds_read_b128 v[116:119], v15 offset:17408
v_mfma_f32_16x16x32_f16 a[12:15], a[156:159], v[20:23], a[12:15]
buffer_load_dwordx4 a[180:183], v4, s[8:11], s20 offen offset:1024
s_waitcnt lgkmcnt(2)
v_pk_fma_f16 v84, v108, s27, v104
v_mfma_f32_16x16x32_f16 a[12:15], a[172:175], v[24:27], a[12:15]
v_pk_fma_f16 v85, v109, s27, v105
v_mfma_f32_16x16x32_f16 a[28:31], a[172:175], v[28:31], a[28:31]
v_pk_fma_f16 v86, v110, s27, v106
v_mfma_f32_16x16x32_f16 a[28:31], a[156:159], v[24:27], a[28:31]
v_pk_fma_f16 v87, v111, s27, v107
v_mfma_f32_16x16x32_f16 a[28:31], a[140:143], v[20:23], a[28:31]
buffer_load_dwordx4 a[196:199], v5, s[8:11], s20 offen offset:1024
v_mfma_f32_16x16x32_f16 a[44:47], a[140:143], v[24:27], a[44:47]
ds_read_b128 v[96:99], v14 offset:19584
v_mfma_f32_16x16x32_f16 a[44:47], a[156:159], v[28:31], a[44:47]
ds_read_b128 v[100:103], v15 offset:19584
v_mfma_f32_16x16x32_f16 a[44:47], a[172:175], v[32:35], a[44:47]
s_waitcnt lgkmcnt(2)
v_pk_fma_f16 v88, v116, s27, v112
v_mfma_f32_16x16x32_f16 a[60:63], a[172:175], v[36:39], a[60:63]
v_pk_fma_f16 v89, v117, s27, v113
v_mfma_f32_16x16x32_f16 a[60:63], a[156:159], v[32:35], a[60:63]
buffer_load_dwordx4 a[212:215], v6, s[8:11], s20 offen offset:1024
v_pk_fma_f16 v90, v118, s27, v114
v_mfma_f32_16x16x32_f16 a[60:63], a[140:143], v[28:31], a[60:63]
v_pk_fma_f16 v91, v119, s27, v115
v_mfma_f32_16x16x32_f16 a[76:79], a[140:143], v[32:35], a[76:79]
buffer_load_dwordx4 v[124:127], v1, s[8:11], s22 offen offset:1024
v_mfma_f32_16x16x32_f16 a[76:79], a[156:159], v[36:39], a[76:79]
s_waitcnt lgkmcnt(0)
v_pk_fma_f16 v92, v100, s27, v96
v_mfma_f32_16x16x32_f16 a[76:79], a[172:175], v[40:43], a[76:79]
v_pk_fma_f16 v93, v101, s27, v97
v_mfma_f32_16x16x32_f16 a[92:95], a[172:175], v[44:47], a[92:95]
v_pk_fma_f16 v94, v102, s27, v98
v_mfma_f32_16x16x32_f16 a[92:95], a[156:159], v[40:43], a[92:95]
v_pk_fma_f16 v95, v103, s27, v99
v_mfma_f32_16x16x32_f16 a[92:95], a[140:143], v[36:39], a[92:95]
buffer_load_dwordx4 a[184:187], v4, s[8:11], s20 offen offset:2048
v_mfma_f32_16x16x32_f16 a[108:111], a[140:143], v[40:43], a[108:111]
v_mfma_f32_16x16x32_f16 a[108:111], a[156:159], v[44:47], a[108:111]
v_mfma_f32_16x16x32_f16 a[108:111], a[172:175], v[48:51], a[108:111]
v_mfma_f32_16x16x32_f16 a[124:127], a[172:175], v[52:55], a[124:127]
buffer_load_dwordx4 a[200:203], v5, s[8:11], s20 offen offset:2048
v_mfma_f32_16x16x32_f16 a[124:127], a[156:159], v[48:51], a[124:127]
v_mfma_f32_16x16x32_f16 a[124:127], a[140:143], v[44:47], a[124:127]
s_waitcnt vmcnt(10)
s_barrier
v_mfma_f32_16x16x32_f16 a[0:3], a[176:179], v[56:59], a[0:3]
ds_read_b128 v[104:107], v14 offset:21760
v_mfma_f32_16x16x32_f16 a[0:3], a[192:195], v[60:63], a[0:3]
ds_read_b128 v[108:111], v15 offset:21760
v_mfma_f32_16x16x32_f16 a[0:3], a[208:211], v[64:67], a[0:3]
buffer_load_dwordx4 a[216:219], v6, s[8:11], s20 offen offset:2048
v_mfma_f32_16x16x32_bf16 a[0:3], v[120:123], a[224:227], a[0:3]
v_mfma_f32_16x16x32_bf16 a[16:19], v[120:123], a[228:231], a[16:19]
v_mfma_f32_16x16x32_f16 a[16:19], a[208:211], v[68:71], a[16:19]
v_mfma_f32_16x16x32_f16 a[16:19], a[192:195], v[64:67], a[16:19]
buffer_load_dwordx4 v[128:131], v1, s[8:11], s22 offen offset:2048
v_mfma_f32_16x16x32_f16 a[16:19], a[176:179], v[60:63], a[16:19]
v_mfma_f32_16x16x32_f16 a[32:35], a[176:179], v[64:67], a[32:35]
v_mfma_f32_16x16x32_f16 a[32:35], a[192:195], v[68:71], a[32:35]
s_waitcnt lgkmcnt(0)
v_pk_fma_f16 v16, v108, s27, v104
v_mfma_f32_16x16x32_f16 a[32:35], a[208:211], v[72:75], a[32:35]
v_pk_fma_f16 v17, v109, s27, v105
v_mfma_f32_16x16x32_bf16 a[32:35], v[120:123], a[232:235], a[32:35]
v_pk_fma_f16 v18, v110, s27, v106
v_mfma_f32_16x16x32_bf16 a[48:51], v[120:123], a[236:239], a[48:51]
buffer_load_dwordx4 a[188:191], v4, s[8:11], s20 offen offset:3072
v_mfma_f32_16x16x32_f16 a[48:51], a[208:211], v[76:79], a[48:51]
ds_read_b128 v[112:115], v14 offset:23936
v_mfma_f32_16x16x32_f16 a[48:51], a[192:195], v[72:75], a[48:51]
v_pk_fma_f16 v19, v111, s27, v107
ds_read_b128 v[116:119], v15 offset:23936
v_mfma_f32_16x16x32_f16 a[48:51], a[176:179], v[68:71], a[48:51]
s_waitcnt vmcnt(9)
v_mfma_f32_16x16x32_f16 a[64:67], a[176:179], v[72:75], a[64:67]
buffer_load_dwordx4 a[204:207], v5, s[8:11], s20 offen offset:3072
v_mfma_f32_16x16x32_f16 a[64:67], a[192:195], v[76:79], a[64:67]
v_mfma_f32_16x16x32_f16 a[64:67], a[208:211], v[80:83], a[64:67]
v_mfma_f32_16x16x32_bf16 a[64:67], v[120:123], a[240:243], a[64:67]
v_mfma_f32_16x16x32_bf16 a[80:83], v[120:123], a[244:247], a[80:83]
s_waitcnt lgkmcnt(0)
v_pk_fma_f16 v20, v116, s27, v112
v_mfma_f32_16x16x32_f16 a[80:83], a[208:211], v[84:87], a[80:83]
buffer_load_dwordx4 a[220:223], v6, s[8:11], s20 offen offset:3072
v_mfma_f32_16x16x32_f16 a[80:83], a[192:195], v[80:83], a[80:83]
v_pk_fma_f16 v21, v117, s27, v113
v_mfma_f32_16x16x32_f16 a[80:83], a[176:179], v[76:79], a[80:83]
s_add_u32 s20, s20, 24576
v_mfma_f32_16x16x32_f16 a[96:99], a[176:179], v[80:83], a[96:99]
v_pk_fma_f16 v22, v118, s27, v114
v_mfma_f32_16x16x32_f16 a[96:99], a[192:195], v[84:87], a[96:99]
ds_read_b128 v[96:99], v14 offset:26112
v_mfma_f32_16x16x32_f16 a[96:99], a[208:211], v[88:91], a[96:99]
v_pk_fma_f16 v23, v119, s27, v115
ds_read_b128 v[100:103], v15 offset:26112
v_mfma_f32_16x16x32_bf16 a[96:99], v[120:123], a[248:251], a[96:99]
buffer_load_dwordx4 v[132:135], v1, s[8:11], s22 offen offset:3072
v_mfma_f32_16x16x32_bf16 a[112:115], v[120:123], a[252:255], a[112:115]
s_add_u32 s22, s22, 4096
v_mfma_f32_16x16x32_f16 a[112:115], a[208:211], v[92:95], a[112:115]
v_mfma_f32_16x16x32_f16 a[112:115], a[192:195], v[88:91], a[112:115]
buffer_load_dwordx4 a[128:131], v1, s[8:11], s20 offen offset:0
v_mfma_f32_16x16x32_f16 a[112:115], a[176:179], v[84:87], a[112:115]
s_waitcnt vmcnt(9)
v_mfma_f32_16x16x32_f16 a[4:7], a[180:183], v[56:59], a[4:7]
s_waitcnt lgkmcnt(0)
v_pk_fma_f16 v24, v100, s27, v96
v_mfma_f32_16x16x32_f16 a[4:7], a[196:199], v[60:63], a[4:7]
v_pk_fma_f16 v25, v101, s27, v97
v_mfma_f32_16x16x32_f16 a[4:7], a[212:215], v[64:67], a[4:7]
v_pk_fma_f16 v26, v102, s27, v98
v_mfma_f32_16x16x32_bf16 a[4:7], v[124:127], a[224:227], a[4:7]
ds_read_b128 v[104:107], v14 offset:28288
v_mfma_f32_16x16x32_bf16 a[20:23], v[124:127], a[228:231], a[20:23]
buffer_load_dwordx4 a[144:147], v2, s[8:11], s20 offen offset:0
v_mfma_f32_16x16x32_f16 a[20:23], a[212:215], v[68:71], a[20:23]
v_pk_fma_f16 v27, v103, s27, v99
v_mfma_f32_16x16x32_f16 a[20:23], a[196:199], v[64:67], a[20:23]
ds_read_b128 v[108:111], v15 offset:28288
v_mfma_f32_16x16x32_f16 a[20:23], a[180:183], v[60:63], a[20:23]
buffer_load_dwordx4 a[160:163], v3, s[8:11], s20 offen offset:0
v_mfma_f32_16x16x32_f16 a[36:39], a[180:183], v[64:67], a[36:39]
v_mfma_f32_16x16x32_f16 a[36:39], a[196:199], v[68:71], a[36:39]
v_mfma_f32_16x16x32_f16 a[36:39], a[212:215], v[72:75], a[36:39]
v_mfma_f32_16x16x32_bf16 a[36:39], v[124:127], a[232:235], a[36:39]
s_waitcnt lgkmcnt(0)
v_pk_fma_f16 v28, v108, s27, v104
v_mfma_f32_16x16x32_bf16 a[52:55], v[124:127], a[236:239], a[52:55]
s_xor_b32 s25, s25, 0x10000
v_mfma_f32_16x16x32_f16 a[52:55], a[212:215], v[76:79], a[52:55]
v_pk_fma_f16 v29, v109, s27, v105
v_mfma_f32_16x16x32_f16 a[52:55], a[196:199], v[72:75], a[52:55]
s_add_u32 m0, s25, 0
v_mfma_f32_16x16x32_f16 a[52:55], a[180:183], v[68:71], a[52:55]
v_pk_fma_f16 v30, v110, s27, v106
v_mfma_f32_16x16x32_f16 a[68:71], a[180:183], v[72:75], a[68:71]
ds_read_b128 v[112:115], v14 offset:30464
buffer_load_dwordx4 v8, s[4:7], s23 offen offset:0 lds
v_mfma_f32_16x16x32_f16 a[68:71], a[196:199], v[76:79], a[68:71]
v_pk_fma_f16 v31, v111, s27, v107
ds_read_b128 v[116:119], v15 offset:30464
v_mfma_f32_16x16x32_f16 a[68:71], a[212:215], v[80:83], a[68:71]
buffer_load_dwordx4 v9, s[4:7], s23 offen offset:1024 lds
v_mfma_f32_16x16x32_bf16 a[68:71], v[124:127], a[240:243], a[68:71]
v_mfma_f32_16x16x32_bf16 a[84:87], v[124:127], a[244:247], a[84:87]
v_mfma_f32_16x16x32_f16 a[84:87], a[212:215], v[84:87], a[84:87]
buffer_load_dwordx4 v10, s[4:7], s23 offen offset:2048 lds
v_mfma_f32_16x16x32_f16 a[84:87], a[196:199], v[80:83], a[84:87]
s_waitcnt lgkmcnt(0)
v_pk_fma_f16 v32, v116, s27, v112
v_mfma_f32_16x16x32_f16 a[84:87], a[180:183], v[76:79], a[84:87]
v_pk_fma_f16 v33, v117, s27, v113
v_mfma_f32_16x16x32_f16 a[100:103], a[180:183], v[80:83], a[100:103]
v_pk_fma_f16 v34, v118, s27, v114
v_mfma_f32_16x16x32_f16 a[100:103], a[196:199], v[84:87], a[100:103]
ds_read_b128 v[96:99], v14 offset:32640
v_mfma_f32_16x16x32_f16 a[100:103], a[212:215], v[88:91], a[100:103]
v_pk_fma_f16 v35, v119, s27, v115
v_mfma_f32_16x16x32_bf16 a[100:103], v[124:127], a[248:251], a[100:103]
ds_read_b128 v[100:103], v15 offset:32640
v_mfma_f32_16x16x32_bf16 a[116:119], v[124:127], a[252:255], a[116:119]
buffer_load_dwordx4 v11, s[4:7], s23 offen offset:3072 lds
v_mfma_f32_16x16x32_f16 a[116:119], a[212:215], v[92:95], a[116:119]
v_mfma_f32_16x16x32_f16 a[116:119], a[196:199], v[88:91], a[116:119]
s_add_u32 m0, s25, 4096
v_mfma_f32_16x16x32_f16 a[116:119], a[180:183], v[84:87], a[116:119]
s_waitcnt vmcnt(11)
v_mfma_f32_16x16x32_f16 a[8:11], a[184:187], v[56:59], a[8:11]
buffer_load_dwordx4 v12, s[4:7], s23 offen offset:0 lds
v_mfma_f32_16x16x32_f16 a[8:11], a[200:203], v[60:63], a[8:11]
v_mfma_f32_16x16x32_f16 a[8:11], a[216:219], v[64:67], a[8:11]
s_waitcnt lgkmcnt(0)
v_pk_fma_f16 v36, v100, s27, v96
v_mfma_f32_16x16x32_bf16 a[8:11], v[128:131], a[224:227], a[8:11]
v_pk_fma_f16 v37, v101, s27, v97
v_mfma_f32_16x16x32_bf16 a[24:27], v[128:131], a[228:231], a[24:27]
s_mov_b64 exec, s[30:31]
buffer_load_dwordx4 v13, s[4:7], s23 offen offset:1024 lds
s_mov_b64 exec, -1
v_mfma_f32_16x16x32_f16 a[24:27], a[216:219], v[68:71], a[24:27]
v_pk_fma_f16 v38, v102, s27, v98
v_mfma_f32_16x16x32_f16 a[24:27], a[200:203], v[64:67], a[24:27]
s_add_u32 s23, s23, 1048576
v_mfma_f32_16x16x32_f16 a[24:27], a[184:187], v[60:63], a[24:27]
ds_read_b128 v[104:107], v14 offset:34816
v_mfma_f32_16x16x32_f16 a[40:43], a[184:187], v[64:67], a[40:43]
v_pk_fma_f16 v39, v103, s27, v99
ds_read_b128 v[108:111], v15 offset:34816
v_mfma_f32_16x16x32_f16 a[40:43], a[200:203], v[68:71], a[40:43]
buffer_load_dwordx4 a[132:135], v1, s[8:11], s20 offen offset:1024
v_mfma_f32_16x16x32_f16 a[40:43], a[216:219], v[72:75], a[40:43]
v_mfma_f32_16x16x32_bf16 a[40:43], v[128:131], a[232:235], a[40:43]
v_mfma_f32_16x16x32_bf16 a[56:59], v[128:131], a[236:239], a[56:59]
buffer_load_dwordx4 a[148:151], v2, s[8:11], s20 offen offset:1024
v_mfma_f32_16x16x32_f16 a[56:59], a[216:219], v[76:79], a[56:59]
s_waitcnt lgkmcnt(0)
v_pk_fma_f16 v40, v108, s27, v104
v_mfma_f32_16x16x32_f16 a[56:59], a[200:203], v[72:75], a[56:59]
v_pk_fma_f16 v41, v109, s27, v105
v_mfma_f32_16x16x32_f16 a[56:59], a[184:187], v[68:71], a[56:59]
v_pk_fma_f16 v42, v110, s27, v106
v_mfma_f32_16x16x32_f16 a[72:75], a[184:187], v[72:75], a[72:75]
ds_read_b128 v[112:115], v14 offset:36992
v_mfma_f32_16x16x32_f16 a[72:75], a[200:203], v[76:79], a[72:75]
v_pk_fma_f16 v43, v111, s27, v107
v_mfma_f32_16x16x32_f16 a[72:75], a[216:219], v[80:83], a[72:75]
ds_read_b128 v[116:119], v15 offset:36992
v_mfma_f32_16x16x32_bf16 a[72:75], v[128:131], a[240:243], a[72:75]
buffer_load_dwordx4 a[164:167], v3, s[8:11], s20 offen offset:1024
v_mfma_f32_16x16x32_bf16 a[88:91], v[128:131], a[244:247], a[88:91]
v_mfma_f32_16x16x32_f16 a[88:91], a[216:219], v[84:87], a[88:91]
v_mfma_f32_16x16x32_f16 a[88:91], a[200:203], v[80:83], a[88:91]
buffer_load_dwordx4 a[136:139], v1, s[8:11], s20 offen offset:2048
v_mfma_f32_16x16x32_f16 a[88:91], a[184:187], v[76:79], a[88:91]
v_mfma_f32_16x16x32_f16 a[104:107], a[184:187], v[80:83], a[104:107]
s_waitcnt lgkmcnt(0)
v_pk_fma_f16 v44, v116, s27, v112
v_mfma_f32_16x16x32_f16 a[104:107], a[200:203], v[84:87], a[104:107]
v_pk_fma_f16 v45, v117, s27, v113
v_mfma_f32_16x16x32_f16 a[104:107], a[216:219], v[88:91], a[104:107]
buffer_load_dwordx4 a[152:155], v2, s[8:11], s20 offen offset:2048
v_mfma_f32_16x16x32_bf16 a[104:107], v[128:131], a[248:251], a[104:107]
v_pk_fma_f16 v46, v118, s27, v114
v_mfma_f32_16x16x32_bf16 a[120:123], v[128:131], a[252:255], a[120:123]
ds_read_b128 v[96:99], v14 offset:39168
v_mfma_f32_16x16x32_f16 a[120:123], a[216:219], v[92:95], a[120:123]
v_pk_fma_f16 v47, v119, s27, v115
v_mfma_f32_16x16x32_f16 a[120:123], a[200:203], v[88:91], a[120:123]
ds_read_b128 v[100:103], v15 offset:39168
v_mfma_f32_16x16x32_f16 a[120:123], a[184:187], v[84:87], a[120:123]
s_waitcnt vmcnt(14)
v_mfma_f32_16x16x32_f16 a[12:15], a[188:191], v[56:59], a[12:15]
buffer_load_dwordx4 a[168:171], v3, s[8:11], s20 offen offset:2048
v_mfma_f32_16x16x32_f16 a[12:15], a[204:207], v[60:63], a[12:15]
v_mfma_f32_16x16x32_f16 a[12:15], a[220:223], v[64:67], a[12:15]
v_mfma_f32_16x16x32_bf16 a[12:15], v[132:135], a[224:227], a[12:15]
v_mfma_f32_16x16x32_bf16 a[28:31], v[132:135], a[228:231], a[28:31]
buffer_load_dwordx4 a[140:143], v1, s[8:11], s20 offen offset:3072
v_mfma_f32_16x16x32_f16 a[28:31], a[220:223], v[68:71], a[28:31]
s_waitcnt lgkmcnt(0)
v_pk_fma_f16 v48, v100, s27, v96
v_mfma_f32_16x16x32_f16 a[28:31], a[204:207], v[64:67], a[28:31]
v_pk_fma_f16 v49, v101, s27, v97
v_mfma_f32_16x16x32_f16 a[28:31], a[188:191], v[60:63], a[28:31]
v_pk_fma_f16 v50, v102, s27, v98
v_mfma_f32_16x16x32_f16 a[44:47], a[188:191], v[64:67], a[44:47]
ds_read_b128 v[104:107], v14 offset:41344
v_mfma_f32_16x16x32_f16 a[44:47], a[204:207], v[68:71], a[44:47]
v_pk_fma_f16 v51, v103, s27, v99
v_mfma_f32_16x16x32_f16 a[44:47], a[220:223], v[72:75], a[44:47]
ds_read_b128 v[108:111], v15 offset:41344
v_mfma_f32_16x16x32_bf16 a[44:47], v[132:135], a[232:235], a[44:47]
buffer_load_dwordx4 a[156:159], v2, s[8:11], s20 offen offset:3072
v_mfma_f32_16x16x32_bf16 a[60:63], v[132:135], a[236:239], a[60:63]
v_mfma_f32_16x16x32_f16 a[60:63], a[220:223], v[76:79], a[60:63]
buffer_load_dwordx4 a[172:175], v3, s[8:11], s20 offen offset:3072
v_mfma_f32_16x16x32_f16 a[60:63], a[204:207], v[72:75], a[60:63]
v_mfma_f32_16x16x32_f16 a[60:63], a[188:191], v[68:71], a[60:63]
s_waitcnt lgkmcnt(0)
v_pk_fma_f16 v52, v108, s27, v104
v_mfma_f32_16x16x32_f16 a[76:79], a[188:191], v[72:75], a[76:79]
v_pk_fma_f16 v53, v109, s27, v105
v_mfma_f32_16x16x32_f16 a[76:79], a[204:207], v[76:79], a[76:79]
v_pk_fma_f16 v54, v110, s27, v106
v_mfma_f32_16x16x32_f16 a[76:79], a[220:223], v[80:83], a[76:79]
s_add_u32 m0, s25, 21760
v_mfma_f32_16x16x32_bf16 a[76:79], v[132:135], a[240:243], a[76:79]
v_pk_fma_f16 v55, v111, s27, v107
v_mfma_f32_16x16x32_bf16 a[92:95], v[132:135], a[244:247], a[92:95]
buffer_load_dwordx4 v8, s[4:7], s24 offen offset:0 lds
v_mfma_f32_16x16x32_f16 a[92:95], a[220:223], v[84:87], a[92:95]
v_mfma_f32_16x16x32_f16 a[92:95], a[204:207], v[80:83], a[92:95]
buffer_load_dwordx4 v9, s[4:7], s24 offen offset:1024 lds
v_mfma_f32_16x16x32_f16 a[92:95], a[188:191], v[76:79], a[92:95]
v_mfma_f32_16x16x32_f16 a[108:111], a[188:191], v[80:83], a[108:111]
v_mfma_f32_16x16x32_f16 a[108:111], a[204:207], v[84:87], a[108:111]
v_mfma_f32_16x16x32_f16 a[108:111], a[220:223], v[88:91], a[108:111]
v_mfma_f32_16x16x32_bf16 a[108:111], v[132:135], a[248:251], a[108:111]
buffer_load_dwordx4 v10, s[4:7], s24 offen offset:2048 lds
v_mfma_f32_16x16x32_bf16 a[124:127], v[132:135], a[252:255], a[124:127]
v_xor_b32 v14, 0x10000, v14
v_mfma_f32_16x16x32_f16 a[124:127], a[220:223], v[92:95], a[124:127]
v_xor_b32 v15, 0x10000, v15
v_mfma_f32_16x16x32_f16 a[124:127], a[204:207], v[88:91], a[124:127]
v_mfma_f32_16x16x32_f16 a[124:127], a[188:191], v[84:87], a[124:127]
s_sub_u32 s26, s26, 1
s_cbranch_scc0 cn_k2_kernel_loop
cn_k2_kernel_fin:
s_waitcnt vmcnt(19)
v_mfma_f32_16x16x32_f16 a[0:3], a[128:131], v[16:19], a[0:3]
v_mfma_f32_16x16x32_f16 a[0:3], a[144:147], v[20:23], a[0:3]
buffer_load_dwordx4 a[176:179], v4, s[8:11], s20 offen offset:0
v_mfma_f32_16x16x32_f16 a[16:19], a[144:147], v[24:27], a[16:19]
v_mfma_f32_16x16x32_f16 a[16:19], a[128:131], v[20:23], a[16:19]
v_mfma_f32_16x16x32_f16 a[32:35], a[128:131], v[24:27], a[32:35]
buffer_load_dwordx4 a[192:195], v5, s[8:11], s20 offen offset:0
v_mfma_f32_16x16x32_f16 a[32:35], a[144:147], v[28:31], a[32:35]
v_mfma_f32_16x16x32_f16 a[48:51], a[144:147], v[32:35], a[48:51]
v_mfma_f32_16x16x32_f16 a[48:51], a[128:131], v[28:31], a[48:51]
s_waitcnt vmcnt(14)
s_barrier
v_mfma_f32_16x16x32_f16 a[64:67], a[128:131], v[32:35], a[64:67]
buffer_load_dwordx4 a[208:211], v6, s[8:11], s20 offen offset:0
v_mfma_f32_16x16x32_f16 a[64:67], a[144:147], v[36:39], a[64:67]
ds_read_b128 v[96:99], v14 offset:0
v_mfma_f32_16x16x32_f16 a[80:83], a[144:147], v[40:43], a[80:83]
ds_read_b128 v[100:103], v15 offset:0
v_mfma_f32_16x16x32_f16 a[80:83], a[128:131], v[36:39], a[80:83]
buffer_load_dwordx4 a[180:183], v4, s[8:11], s20 offen offset:1024
v_mfma_f32_16x16x32_f16 a[96:99], a[128:131], v[40:43], a[96:99]
v_mfma_f32_16x16x32_f16 a[96:99], a[144:147], v[44:47], a[96:99]
v_mfma_f32_16x16x32_f16 a[112:115], a[144:147], v[48:51], a[112:115]
v_mfma_f32_16x16x32_f16 a[112:115], a[128:131], v[44:47], a[112:115]
s_waitcnt vmcnt(14)
v_mfma_f32_16x16x32_f16 a[4:7], a[132:135], v[16:19], a[4:7]
buffer_load_dwordx4 a[196:199], v5, s[8:11], s20 offen offset:1024
v_mfma_f32_16x16x32_f16 a[4:7], a[148:151], v[20:23], a[4:7]
ds_read_b128 v[104:107], v14 offset:2176
v_mfma_f32_16x16x32_f16 a[20:23], a[148:151], v[24:27], a[20:23]
s_waitcnt lgkmcnt(1)
v_pk_fma_f16 v56, v100, s27, v96
v_mfma_f32_16x16x32_f16 a[20:23], a[132:135], v[20:23], a[20:23]
ds_read_b128 v[108:111], v15 offset:2176
v_mfma_f32_16x16x32_f16 a[36:39], a[132:135], v[24:27], a[36:39]
v_pk_fma_f16 v57, v101, s27, v97
v_mfma_f32_16x16x32_f16 a[36:39], a[148:151], v[28:31], a[36:39]
buffer_load_dwordx4 a[212:215], v6, s[8:11], s20 offen offset:1024
v_mfma_f32_16x16x32_f16 a[52:55], a[148:151], v[32:35], a[52:55]
v_pk_fma_f16 v58, v102, s27, v98
v_mfma_f32_16x16x32_f16 a[52:55], a[132:135], v[28:31], a[52:55]
v_pk_fma_f16 v59, v103, s27, v99
v_mfma_f32_16x16x32_f16 a[68:71], a[132:135], v[32:35], a[68:71]
buffer_load_dwordx4 a[184:187], v4, s[8:11], s20 offen offset:2048
v_mfma_f32_16x16x32_f16 a[68:71], a[148:151], v[36:39], a[68:71]
ds_read_b128 v[112:115], v14 offset:4352
v_mfma_f32_16x16x32_f16 a[84:87], a[148:151], v[40:43], a[84:87]
s_waitcnt lgkmcnt(1)
v_pk_fma_f16 v60, v108, s27, v104
v_mfma_f32_16x16x32_f16 a[84:87], a[132:135], v[36:39], a[84:87]
buffer_load_dwordx4 a[200:203], v5, s[8:11], s20 offen offset:2048
v_mfma_f32_16x16x32_f16 a[100:103], a[132:135], v[40:43], a[100:103]
ds_read_b128 v[116:119], v15 offset:4352
v_mfma_f32_16x16x32_f16 a[100:103], a[148:151], v[44:47], a[100:103]
v_pk_fma_f16 v61, v109, s27, v105
v_mfma_f32_16x16x32_f16 a[116:119], a[148:151], v[48:51], a[116:119]
v_pk_fma_f16 v62, v110, s27, v106
v_pk_fma_f16 v63, v111, s27, v107
v_mfma_f32_16x16x32_f16 a[116:119], a[132:135], v[44:47], a[116:119]
s_waitcnt vmcnt(15)
v_mfma_f32_16x16x32_f16 a[8:11], a[136:139], v[16:19], a[8:11]
buffer_load_dwordx4 a[216:219], v6, s[8:11], s20 offen offset:2048
v_mfma_f32_16x16x32_f16 a[8:11], a[152:155], v[20:23], a[8:11]
buffer_load_dwordx4 a[188:191], v4, s[8:11], s20 offen offset:3072
v_mfma_f32_16x16x32_f16 a[24:27], a[152:155], v[24:27], a[24:27]
ds_read_b128 v[96:99], v14 offset:6528
v_mfma_f32_16x16x32_f16 a[24:27], a[136:139], v[20:23], a[24:27]
s_waitcnt lgkmcnt(1)
v_pk_fma_f16 v64, v116, s27, v112
v_mfma_f32_16x16x32_f16 a[40:43], a[136:139], v[24:27], a[40:43]
ds_read_b128 v[100:103], v15 offset:6528
v_mfma_f32_16x16x32_f16 a[40:43], a[152:155], v[28:31], a[40:43]
v_pk_fma_f16 v65, v117, s27, v113
v_mfma_f32_16x16x32_f16 a[56:59], a[152:155], v[32:35], a[56:59]
v_pk_fma_f16 v66, v118, s27, v114
v_mfma_f32_16x16x32_f16 a[56:59], a[136:139], v[28:31], a[56:59]
buffer_load_dwordx4 a[204:207], v5, s[8:11], s20 offen offset:3072
v_pk_fma_f16 v67, v119, s27, v115
v_mfma_f32_16x16x32_f16 a[72:75], a[136:139], v[32:35], a[72:75]
buffer_load_dwordx4 a[220:223], v6, s[8:11], s20 offen offset:3072
v_mfma_f32_16x16x32_f16 a[72:75], a[152:155], v[36:39], a[72:75]
ds_read_b128 v[104:107], v14 offset:8704
v_mfma_f32_16x16x32_f16 a[88:91], a[152:155], v[40:43], a[88:91]
s_waitcnt lgkmcnt(1)
v_pk_fma_f16 v68, v100, s27, v96
v_mfma_f32_16x16x32_f16 a[88:91], a[136:139], v[36:39], a[88:91]
ds_read_b128 v[108:111], v15 offset:8704
v_mfma_f32_16x16x32_f16 a[104:107], a[136:139], v[40:43], a[104:107]
buffer_load_dwordx4 v[136:139], v232, s[12:15], s32 offen offset:0
v_mfma_f32_16x16x32_f16 a[104:107], a[152:155], v[44:47], a[104:107]
v_pk_fma_f16 v69, v101, s27, v97
v_mfma_f32_16x16x32_f16 a[120:123], a[152:155], v[48:51], a[120:123]
v_pk_fma_f16 v70, v102, s27, v98
v_mfma_f32_16x16x32_f16 a[120:123], a[136:139], v[44:47], a[120:123]
s_waitcnt vmcnt(17)
v_mfma_f32_16x16x32_f16 a[12:15], a[140:143], v[16:19], a[12:15]
v_pk_fma_f16 v71, v103, s27, v99
v_mfma_f32_16x16x32_f16 a[12:15], a[156:159], v[20:23], a[12:15]
buffer_load_dwordx4 v[140:143], v232, s[12:15], s32 offen offset:1024
v_mfma_f32_16x16x32_f16 a[28:31], a[156:159], v[24:27], a[28:31]
ds_read_b128 v[112:115], v14 offset:10880
v_mfma_f32_16x16x32_f16 a[28:31], a[140:143], v[20:23], a[28:31]
s_waitcnt lgkmcnt(1)
v_pk_fma_f16 v72, v108, s27, v104
v_mfma_f32_16x16x32_f16 a[44:47], a[140:143], v[24:27], a[44:47]
ds_read_b128 v[116:119], v15 offset:10880
v_mfma_f32_16x16x32_f16 a[44:47], a[156:159], v[28:31], a[44:47]
buffer_load_dwordx4 v[144:147], v232, s[12:15], s33 offen offset:0
v_mfma_f32_16x16x32_f16 a[60:63], a[156:159], v[32:35], a[60:63]
v_pk_fma_f16 v73, v109, s27, v105
v_mfma_f32_16x16x32_f16 a[60:63], a[140:143], v[28:31], a[60:63]
v_pk_fma_f16 v74, v110, s27, v106
v_mfma_f32_16x16x32_f16 a[76:79], a[140:143], v[32:35], a[76:79]
v_pk_fma_f16 v75, v111, s27, v107
v_mfma_f32_16x16x32_f16 a[76:79], a[156:159], v[36:39], a[76:79]
buffer_load_dwordx4 v[148:151], v232, s[12:15], s33 offen offset:1024
v_mfma_f32_16x16x32_f16 a[92:95], a[156:159], v[40:43], a[92:95]
ds_read_b128 v[96:99], v14 offset:13056
v_mfma_f32_16x16x32_f16 a[92:95], a[140:143], v[36:39], a[92:95]
s_waitcnt lgkmcnt(1)
v_pk_fma_f16 v76, v116, s27, v112
v_mfma_f32_16x16x32_f16 a[108:111], a[140:143], v[40:43], a[108:111]
buffer_load_dwordx4 v[152:155], v232, s[12:15], s34 offen offset:0
v_mfma_f32_16x16x32_f16 a[108:111], a[156:159], v[44:47], a[108:111]
ds_read_b128 v[100:103], v15 offset:13056
v_mfma_f32_16x16x32_f16 a[124:127], a[156:159], v[48:51], a[124:127]
v_pk_fma_f16 v77, v117, s27, v113
v_mfma_f32_16x16x32_f16 a[124:127], a[140:143], v[44:47], a[124:127]
s_waitcnt vmcnt(14)
v_mfma_f32_16x16x32_f16 a[0:3], a[160:163], v[24:27], a[0:3]
v_pk_fma_f16 v78, v118, s27, v114
v_mfma_f32_16x16x32_f16 a[0:3], a[176:179], v[56:59], a[0:3]
v_pk_fma_f16 v79, v119, s27, v115
v_mfma_f32_16x16x32_f16 a[0:3], a[192:195], v[60:63], a[0:3]
buffer_load_dwordx4 v[156:159], v232, s[12:15], s34 offen offset:1024
v_mfma_f32_16x16x32_f16 a[0:3], a[208:211], v[64:67], a[0:3]
s_waitcnt vmcnt(12)
v_mfma_f32_16x16x32_f16 a[4:7], a[164:167], v[24:27], a[4:7]
ds_read_b128 v[104:107], v14 offset:15232
v_mfma_f32_16x16x32_f16 a[4:7], a[180:183], v[56:59], a[4:7]
buffer_load_dwordx4 v[160:163], v232, s[12:15], s35 offen offset:0
v_mfma_f32_16x16x32_f16 a[4:7], a[196:199], v[60:63], a[4:7]
s_waitcnt lgkmcnt(1)
v_pk_fma_f16 v80, v100, s27, v96
ds_read_b128 v[108:111], v15 offset:15232
v_mfma_f32_16x16x32_f16 a[4:7], a[212:215], v[64:67], a[4:7]
v_pk_fma_f16 v81, v101, s27, v97
s_waitcnt vmcnt(10)
v_mfma_f32_16x16x32_f16 a[8:11], a[168:171], v[24:27], a[8:11]
v_pk_fma_f16 v82, v102, s27, v98
v_mfma_f32_16x16x32_f16 a[8:11], a[184:187], v[56:59], a[8:11]
v_pk_fma_f16 v83, v103, s27, v99
v_mfma_f32_16x16x32_f16 a[8:11], a[200:203], v[60:63], a[8:11]
buffer_load_dwordx4 v[164:167], v232, s[12:15], s35 offen offset:1024
v_mfma_f32_16x16x32_f16 a[8:11], a[216:219], v[64:67], a[8:11]
s_waitcnt vmcnt(8)
v_mfma_f32_16x16x32_f16 a[12:15], a[172:175], v[24:27], a[12:15]
ds_read_b128 v[112:115], v14 offset:17408
v_mfma_f32_16x16x32_f16 a[12:15], a[188:191], v[56:59], a[12:15]
s_waitcnt lgkmcnt(1)
v_pk_fma_f16 v84, v108, s27, v104
v_mfma_f32_16x16x32_f16 a[12:15], a[204:207], v[60:63], a[12:15]
ds_write_b128 v233, a[0:3] offset:0
v_mfma_f32_16x16x32_f16 a[12:15], a[220:223], v[64:67], a[12:15]
ds_read_b128 v[116:119], v15 offset:17408
v_pk_fma_f16 v85, v109, s27, v105
v_mfma_f32_16x16x32_f16 a[16:19], a[160:163], v[28:31], a[16:19]
v_pk_fma_f16 v86, v110, s27, v106
v_mfma_f32_16x16x32_f16 a[16:19], a[176:179], v[60:63], a[16:19]
v_pk_fma_f16 v87, v111, s27, v107
v_mfma_f32_16x16x32_f16 a[16:19], a[192:195], v[64:67], a[16:19]
ds_write_b128 v234, a[4:7] offset:0
v_mfma_f32_16x16x32_f16 a[16:19], a[208:211], v[68:71], a[16:19]
ds_read_b128 v[96:99], v14 offset:19584
v_mfma_f32_16x16x32_f16 a[20:23], a[164:167], v[28:31], a[20:23]
ds_write_b128 v233, a[8:11] offset:128
v_mfma_f32_16x16x32_f16 a[20:23], a[180:183], v[60:63], a[20:23]
s_waitcnt lgkmcnt(3)
v_pk_fma_f16 v88, v116, s27, v112
v_mfma_f32_16x16x32_f16 a[20:23], a[196:199], v[64:67], a[20:23]
ds_read_b128 v[100:103], v15 offset:19584
v_mfma_f32_16x16x32_f16 a[20:23], a[212:215], v[68:71], a[20:23]
v_pk_fma_f16 v89, v117, s27, v113
v_mfma_f32_16x16x32_f16 a[24:27], a[168:171], v[28:31], a[24:27]
v_pk_fma_f16 v90, v118, s27, v114
v_mfma_f32_16x16x32_f16 a[24:27], a[184:187], v[60:63], a[24:27]
v_pk_fma_f16 v91, v119, s27, v115
v_mfma_f32_16x16x32_f16 a[24:27], a[200:203], v[64:67], a[24:27]
ds_write_b128 v234, a[12:15] offset:128
v_mfma_f32_16x16x32_f16 a[24:27], a[216:219], v[68:71], a[24:27]
v_mfma_f32_16x16x32_f16 a[28:31], a[172:175], v[28:31], a[28:31]
ds_write_b128 v233, a[16:19] offset:16384
v_mfma_f32_16x16x32_f16 a[28:31], a[188:191], v[60:63], a[28:31]
s_waitcnt lgkmcnt(2)
v_pk_fma_f16 v92, v100, s27, v96
v_mfma_f32_16x16x32_f16 a[28:31], a[204:207], v[64:67], a[28:31]
v_pk_fma_f16 v93, v101, s27, v97
v_mfma_f32_16x16x32_f16 a[28:31], a[220:223], v[68:71], a[28:31]
v_pk_fma_f16 v94, v102, s27, v98
v_mfma_f32_16x16x32_f16 a[32:35], a[160:163], v[32:35], a[32:35]
v_pk_fma_f16 v95, v103, s27, v99
v_mfma_f32_16x16x32_f16 a[32:35], a[176:179], v[64:67], a[32:35]
ds_write_b128 v234, a[20:23] offset:16384
v_mfma_f32_16x16x32_f16 a[32:35], a[192:195], v[68:71], a[32:35]
v_mfma_f32_16x16x32_f16 a[32:35], a[208:211], v[72:75], a[32:35]
v_mfma_f32_16x16x32_f16 a[36:39], a[164:167], v[32:35], a[36:39]
ds_write_b128 v233, a[24:27] offset:16512
v_mfma_f32_16x16x32_f16 a[36:39], a[180:183], v[64:67], a[36:39]
v_mfma_f32_16x16x32_f16 a[36:39], a[196:199], v[68:71], a[36:39]
v_mfma_f32_16x16x32_f16 a[36:39], a[212:215], v[72:75], a[36:39]
v_mfma_f32_16x16x32_f16 a[40:43], a[168:171], v[32:35], a[40:43]
ds_write_b128 v234, a[28:31] offset:16512
v_mfma_f32_16x16x32_f16 a[40:43], a[184:187], v[64:67], a[40:43]
v_mfma_f32_16x16x32_f16 a[40:43], a[200:203], v[68:71], a[40:43]
v_mfma_f32_16x16x32_f16 a[40:43], a[216:219], v[72:75], a[40:43]
v_mfma_f32_16x16x32_f16 a[44:47], a[172:175], v[32:35], a[44:47]
ds_write_b128 v233, a[32:35] offset:32768
s_waitcnt vmcnt(20) lgkmcnt(1)
s_barrier
v_mfma_f32_16x16x32_f16 a[44:47], a[188:191], v[64:67], a[44:47]
ds_read_b128 v[168:171], v250 offset:0
ds_read_b128 v[172:175], v251 offset:0
v_mfma_f32_16x16x32_f16 a[44:47], a[204:207], v[68:71], a[44:47]
ds_read_b128 v[176:179], v250 offset:4096
ds_read_b128 v[180:183], v251 offset:4096
v_mfma_f32_16x16x32_f16 a[44:47], a[220:223], v[72:75], a[44:47]
ds_read_b128 v[184:187], v250 offset:8192
ds_read_b128 v[188:191], v251 offset:8192
v_mfma_f32_16x16x32_f16 a[48:51], a[160:163], v[36:39], a[48:51]
ds_read_b128 v[192:195], v250 offset:12288
ds_read_b128 v[196:199], v251 offset:12288
v_mfma_f32_16x16x32_f16 a[48:51], a[176:179], v[68:71], a[48:51]
ds_write_b128 v234, a[36:39] offset:32768
s_waitcnt vmcnt(6)
v_mfma_f32_16x16x32_f16 a[48:51], a[192:195], v[72:75], a[48:51]
v_lshlrev_b32 v238, 16, v136
v_and_b32 v239, 0xffff0000, v136
v_mfma_f32_16x16x32_f16 a[48:51], a[208:211], v[76:79], a[48:51]
v_lshlrev_b32 v240, 16, v140
v_and_b32 v241, 0xffff0000, v140
v_mfma_f32_16x16x32_f16 a[52:55], a[164:167], v[36:39], a[52:55]
s_waitcnt lgkmcnt(1)
v_fmac_f32 v238, s28, v168
v_mfma_f32_16x16x32_f16 a[52:55], a[180:183], v[68:71], a[52:55]
v_fmac_f32 v239, s28, v169
ds_write_b128 v233, a[40:43] offset:32896
v_mfma_f32_16x16x32_f16 a[52:55], a[196:199], v[72:75], a[52:55]
v_fmac_f32 v240, s28, v176
v_fmac_f32 v241, s28, v177
v_mfma_f32_16x16x32_f16 a[52:55], a[212:215], v[76:79], a[52:55]
v_fmac_f32 v238, s28, v176
v_fmac_f32 v239, s28, v177
v_mfma_f32_16x16x32_f16 a[56:59], a[168:171], v[36:39], a[56:59]
v_fmac_f32 v240, s82, v184
v_fmac_f32 v241, s82, v185
v_mfma_f32_16x16x32_f16 a[56:59], a[184:187], v[68:71], a[56:59]
v_fmac_f32 v238, s28, v184
v_fmac_f32 v239, s28, v185
v_mfma_f32_16x16x32_f16 a[56:59], a[200:203], v[72:75], a[56:59]
ds_write_b128 v234, a[44:47] offset:32896
v_fmac_f32 v240, s82, v192
v_mfma_f32_16x16x32_f16 a[56:59], a[216:219], v[76:79], a[56:59]
v_fmac_f32 v241, s82, v193
v_cvt_pk_bf16_f32 v120, v238, v239
v_mfma_f32_16x16x32_f16 a[60:63], a[172:175], v[36:39], a[60:63]
v_cvt_pk_bf16_f32 v124, v240, v241
v_lshlrev_b32 v242, 16, v137
v_mfma_f32_16x16x32_f16 a[60:63], a[188:191], v[68:71], a[60:63]
v_and_b32 v243, 0xffff0000, v137
v_lshlrev_b32 v244, 16, v141
v_mfma_f32_16x16x32_f16 a[60:63], a[204:207], v[72:75], a[60:63]
v_and_b32 v245, 0xffff0000, v141
ds_write_b128 v233, a[48:51] offset:49152
v_mfma_f32_16x16x32_f16 a[60:63], a[220:223], v[76:79], a[60:63]
v_fmac_f32 v242, s28, v170
v_fmac_f32 v243, s28, v171
v_mfma_f32_16x16x32_f16 a[64:67], a[160:163], v[40:43], a[64:67]
v_fmac_f32 v244, s28, v178
v_fmac_f32 v245, s28, v179
v_mfma_f32_16x16x32_f16 a[64:67], a[176:179], v[72:75], a[64:67]
v_fmac_f32 v242, s28, v178
v_fmac_f32 v243, s28, v179
v_mfma_f32_16x16x32_f16 a[64:67], a[192:195], v[76:79], a[64:67]
v_fmac_f32 v244, s82, v186
v_fmac_f32 v245, s82, v187
v_mfma_f32_16x16x32_f16 a[64:67], a[208:211], v[80:83], a[64:67]
ds_write_b128 v234, a[52:55] offset:49152
v_fmac_f32 v242, s28, v186
v_fmac_f32 v243, s28, v187
v_mfma_f32_16x16x32_f16 a[68:71], a[164:167], v[40:43], a[68:71]
v_fmac_f32 v244, s82, v194
v_fmac_f32 v245, s82, v195
v_mfma_f32_16x16x32_f16 a[68:71], a[180:183], v[72:75], a[68:71]
v_cvt_pk_bf16_f32 v121, v242, v243
v_cvt_pk_bf16_f32 v125, v244, v245
v_mfma_f32_16x16x32_f16 a[68:71], a[196:199], v[76:79], a[68:71]
v_lshlrev_b32 v238, 16, v138
v_and_b32 v239, 0xffff0000, v138
v_mfma_f32_16x16x32_f16 a[68:71], a[212:215], v[80:83], a[68:71]
ds_write_b128 v233, a[56:59] offset:49280
v_lshlrev_b32 v240, 16, v142
v_and_b32 v241, 0xffff0000, v142
v_mfma_f32_16x16x32_f16 a[72:75], a[168:171], v[40:43], a[72:75]
v_fmac_f32 v238, s28, v172
v_fmac_f32 v239, s28, v173
v_mfma_f32_16x16x32_f16 a[72:75], a[184:187], v[72:75], a[72:75]
v_fmac_f32 v240, s28, v180
v_fmac_f32 v241, s28, v181
v_mfma_f32_16x16x32_f16 a[72:75], a[200:203], v[76:79], a[72:75]
v_fmac_f32 v238, s28, v180
v_fmac_f32 v239, s28, v181
v_mfma_f32_16x16x32_f16 a[72:75], a[216:219], v[80:83], a[72:75]
ds_write_b128 v234, a[60:63] offset:49280
v_fmac_f32 v240, s82, v188
v_fmac_f32 v241, s82, v189
v_mfma_f32_16x16x32_f16 a[76:79], a[172:175], v[40:43], a[76:79]
v_fmac_f32 v238, s28, v188
v_fmac_f32 v239, s28, v189
v_mfma_f32_16x16x32_f16 a[76:79], a[188:191], v[72:75], a[76:79]
v_fmac_f32 v240, s82, v196
v_fmac_f32 v241, s82, v197
v_mfma_f32_16x16x32_f16 a[76:79], a[204:207], v[76:79], a[76:79]
v_cvt_pk_bf16_f32 v122, v238, v239
v_cvt_pk_bf16_f32 v126, v240, v241
v_mfma_f32_16x16x32_f16 a[76:79], a[220:223], v[80:83], a[76:79]
ds_write_b128 v235, a[64:67] offset:0
s_waitcnt lgkmcnt(1)
s_barrier
v_lshlrev_b32 v242, 16, v139
v_and_b32 v243, 0xffff0000, v139
v_mfma_f32_16x16x32_f16 a[80:83], a[160:163], v[44:47], a[80:83]
v_lshlrev_b32 v244, 16, v143
v_and_b32 v245, 0xffff0000, v143
v_mfma_f32_16x16x32_f16 a[80:83], a[176:179], v[76:79], a[80:83]
v_fmac_f32 v242, s28, v174
v_fmac_f32 v243, s28, v175
v_mfma_f32_16x16x32_f16 a[80:83], a[192:195], v[80:83], a[80:83]
v_fmac_f32 v244, s28, v182
v_fmac_f32 v245, s28, v183
v_mfma_f32_16x16x32_f16 a[80:83], a[208:211], v[84:87], a[80:83]
ds_write_b128 v236, a[68:71] offset:0
v_fmac_f32 v242, s28, v182
v_fmac_f32 v243, s28, v183
v_mfma_f32_16x16x32_f16 a[84:87], a[164:167], v[44:47], a[84:87]
v_fmac_f32 v244, s82, v190
v_fmac_f32 v245, s82, v191
v_mfma_f32_16x16x32_f16 a[84:87], a[180:183], v[76:79], a[84:87]
v_fmac_f32 v242, s28, v190
v_fmac_f32 v243, s28, v191
v_mfma_f32_16x16x32_f16 a[84:87], a[196:199], v[80:83], a[84:87]
v_fmac_f32 v244, s82, v198
v_fmac_f32 v245, s82, v199
v_mfma_f32_16x16x32_f16 a[84:87], a[212:215], v[84:87], a[84:87]
ds_write_b128 v235, a[72:75] offset:128
v_cvt_pk_bf16_f32 v123, v242, v243
v_cvt_pk_bf16_f32 v127, v244, v245
v_mfma_f32_16x16x32_f16 a[88:91], a[168:171], v[44:47], a[88:91]
buffer_store_dwordx4 v[120:123], v232, s[16:19], s32 offen sc1
buffer_store_dwordx4 v[124:127], v232, s[16:19], s32 offen offset:1024 sc1
v_mfma_f32_16x16x32_f16 a[88:91], a[184:187], v[76:79], a[88:91]
ds_read_b128 v[168:171], v250 offset:32768
ds_read_b128 v[172:175], v251 offset:32768
ds_read_b128 v[176:179], v250 offset:36864
v_mfma_f32_16x16x32_f16 a[88:91], a[200:203], v[80:83], a[88:91]
ds_read_b128 v[180:183], v251 offset:36864
ds_read_b128 v[184:187], v250 offset:40960
v_mfma_f32_16x16x32_f16 a[88:91], a[216:219], v[84:87], a[88:91]
ds_write_b128 v236, a[76:79] offset:128
ds_read_b128 v[188:191], v251 offset:40960
ds_read_b128 v[192:195], v250 offset:45056
v_mfma_f32_16x16x32_f16 a[92:95], a[172:175], v[44:47], a[92:95]
ds_read_b128 v[196:199], v251 offset:45056
s_waitcnt vmcnt(6)
v_mfma_f32_16x16x32_f16 a[92:95], a[188:191], v[76:79], a[92:95]
v_lshlrev_b32 v238, 16, v144
v_and_b32 v239, 0xffff0000, v144
v_mfma_f32_16x16x32_f16 a[92:95], a[204:207], v[80:83], a[92:95]
v_lshlrev_b32 v240, 16, v148
v_and_b32 v241, 0xffff0000, v148
v_mfma_f32_16x16x32_f16 a[92:95], a[220:223], v[84:87], a[92:95]
ds_write_b128 v235, a[80:83] offset:16384
s_waitcnt lgkmcnt(1)
v_fmac_f32 v238, s28, v168
v_mfma_f32_16x16x32_f16 a[96:99], a[160:163], v[48:51], a[96:99]
v_fmac_f32 v239, s28, v169
v_fmac_f32 v240, s28, v176
v_mfma_f32_16x16x32_f16 a[96:99], a[176:179], v[80:83], a[96:99]
v_fmac_f32 v241, s28, v177
v_fmac_f32 v238, s28, v176
v_mfma_f32_16x16x32_f16 a[96:99], a[192:195], v[84:87], a[96:99]
v_fmac_f32 v239, s28, v177
v_fmac_f32 v240, s82, v184
v_mfma_f32_16x16x32_f16 a[96:99], a[208:211], v[88:91], a[96:99]
ds_write_b128 v236, a[84:87] offset:16384
v_fmac_f32 v241, s82, v185
v_fmac_f32 v238, s28, v184
v_mfma_f32_16x16x32_f16 a[100:103], a[164:167], v[48:51], a[100:103]
v_fmac_f32 v239, s28, v185
v_fmac_f32 v240, s82, v192
v_mfma_f32_16x16x32_f16 a[100:103], a[180:183], v[80:83], a[100:103]
v_fmac_f32 v241, s82, v193
v_cvt_pk_bf16_f32 v128, v238, v239
v_mfma_f32_16x16x32_f16 a[100:103], a[196:199], v[84:87], a[100:103]
v_cvt_pk_bf16_f32 v132, v240, v241
v_lshlrev_b32 v242, 16, v145
v_mfma_f32_16x16x32_f16 a[100:103], a[212:215], v[88:91], a[100:103]
ds_write_b128 v235, a[88:91] offset:16512
v_and_b32 v243, 0xffff0000, v145
v_lshlrev_b32 v244, 16, v149
v_mfma_f32_16x16x32_f16 a[104:107], a[168:171], v[48:51], a[104:107]
v_and_b32 v245, 0xffff0000, v149
v_fmac_f32 v242, s28, v170
v_mfma_f32_16x16x32_f16 a[104:107], a[184:187], v[80:83], a[104:107]
v_fmac_f32 v243, s28, v171
v_fmac_f32 v244, s28, v178
v_mfma_f32_16x16x32_f16 a[104:107], a[200:203], v[84:87], a[104:107]
v_fmac_f32 v245, s28, v179
v_fmac_f32 v242, s28, v178
v_mfma_f32_16x16x32_f16 a[104:107], a[216:219], v[88:91], a[104:107]
ds_write_b128 v236, a[92:95] offset:16512
v_fmac_f32 v243, s28, v179
v_fmac_f32 v244, s82, v186
v_mfma_f32_16x16x32_f16 a[108:111], a[172:175], v[48:51], a[108:111]
v_fmac_f32 v245, s82, v187
v_fmac_f32 v242, s28, v186
v_mfma_f32_16x16x32_f16 a[108:111], a[188:191], v[80:83], a[108:111]
v_fmac_f32 v243, s28, v187
v_fmac_f32 v244, s82, v194
v_mfma_f32_16x16x32_f16 a[108:111], a[204:207], v[84:87], a[108:111]
v_fmac_f32 v245, s82, v195
v_cvt_pk_bf16_f32 v129, v242, v243
v_mfma_f32_16x16x32_f16 a[108:111], a[220:223], v[88:91], a[108:111]
ds_write_b128 v235, a[96:99] offset:32768
v_cvt_pk_bf16_f32 v133, v244, v245
v_lshlrev_b32 v238, 16, v146
v_mfma_f32_16x16x32_f16 a[112:115], a[160:163], v[52:55], a[112:115]
v_and_b32 v239, 0xffff0000, v146
v_lshlrev_b32 v240, 16, v150
v_mfma_f32_16x16x32_f16 a[112:115], a[176:179], v[84:87], a[112:115]
v_and_b32 v241, 0xffff0000, v150
v_fmac_f32 v238, s28, v172
v_mfma_f32_16x16x32_f16 a[112:115], a[192:195], v[88:91], a[112:115]
v_fmac_f32 v239, s28, v173
v_fmac_f32 v240, s28, v180
v_mfma_f32_16x16x32_f16 a[112:115], a[208:211], v[92:95], a[112:115]
ds_write_b128 v236, a[100:103] offset:32768
v_fmac_f32 v241, s28, v181
v_fmac_f32 v238, s28, v180
v_mfma_f32_16x16x32_f16 a[116:119], a[164:167], v[52:55], a[116:119]
v_fmac_f32 v239, s28, v181
v_fmac_f32 v240, s82, v188
v_mfma_f32_16x16x32_f16 a[116:119], a[180:183], v[84:87], a[116:119]
v_fmac_f32 v241, s82, v189
v_fmac_f32 v238, s28, v188
v_mfma_f32_16x16x32_f16 a[116:119], a[196:199], v[88:91], a[116:119]
v_fmac_f32 v239, s28, v189
v_fmac_f32 v240, s82, v196
v_mfma_f32_16x16x32_f16 a[116:119], a[212:215], v[92:95], a[116:119]
ds_write_b128 v235, a[104:107] offset:32896
v_fmac_f32 v241, s82, v197
v_cvt_pk_bf16_f32 v130, v238, v239
v_mfma_f32_16x16x32_f16 a[120:123], a[168:171], v[52:55], a[120:123]
v_cvt_pk_bf16_f32 v134, v240, v241
v_lshlrev_b32 v242, 16, v147
v_mfma_f32_16x16x32_f16 a[120:123], a[184:187], v[84:87], a[120:123]
v_and_b32 v243, 0xffff0000, v147
v_lshlrev_b32 v244, 16, v151
v_mfma_f32_16x16x32_f16 a[120:123], a[200:203], v[88:91], a[120:123]
v_and_b32 v245, 0xffff0000, v151
v_fmac_f32 v242, s28, v174
v_mfma_f32_16x16x32_f16 a[120:123], a[216:219], v[92:95], a[120:123]
ds_write_b128 v236, a[108:111] offset:32896
v_fmac_f32 v243, s28, v175
v_fmac_f32 v244, s28, v182
v_mfma_f32_16x16x32_f16 a[124:127], a[172:175], v[52:55], a[124:127]
v_fmac_f32 v245, s28, v183
v_fmac_f32 v242, s28, v182
v_mfma_f32_16x16x32_f16 a[124:127], a[188:191], v[84:87], a[124:127]
v_fmac_f32 v243, s28, v183
v_fmac_f32 v244, s82, v190
v_mfma_f32_16x16x32_f16 a[124:127], a[204:207], v[88:91], a[124:127]
v_fmac_f32 v245, s82, v191
v_fmac_f32 v242, s28, v190
v_mfma_f32_16x16x32_f16 a[124:127], a[220:223], v[92:95], a[124:127]
ds_write_b128 v235, a[112:115] offset:49152
v_fmac_f32 v243, s28, v191
v_fmac_f32 v244, s82, v198
v_fmac_f32 v245, s82, v199
v_cvt_pk_bf16_f32 v131, v242, v243
v_cvt_pk_bf16_f32 v135, v244, v245
buffer_store_dwordx4 v[128:131], v232, s[16:19], s33 offen sc1
ds_write_b128 v236, a[116:119] offset:49152
buffer_store_dwordx4 v[132:135], v232, s[16:19], s33 offen offset:1024 sc1
s_nop 3
ds_write_b128 v235, a[120:123] offset:49280
s_nop 2
ds_write_b128 v236, a[124:127] offset:49280
s_waitcnt lgkmcnt(0)
s_barrier
ds_read_b128 v[16:19], v252 offset:0
ds_read_b128 v[20:23], v253 offset:0
ds_read_b128 v[24:27], v252 offset:4096
ds_read_b128 v[28:31], v253 offset:4096
ds_read_b128 v[32:35], v252 offset:8192
ds_read_b128 v[36:39], v253 offset:8192
ds_read_b128 v[40:43], v252 offset:12288
ds_read_b128 v[44:47], v253 offset:12288
s_waitcnt vmcnt(6)
v_lshlrev_b32 v238, 16, v152
v_and_b32 v239, 0xffff0000, v152
v_lshlrev_b32 v240, 16, v156
v_and_b32 v241, 0xffff0000, v156
s_waitcnt lgkmcnt(0)
ds_read_b128 v[48:51], v252 offset:32768
ds_read_b128 v[52:55], v253 offset:32768
ds_read_b128 v[56:59], v252 offset:36864
ds_read_b128 v[60:63], v253 offset:36864
ds_read_b128 v[64:67], v252 offset:40960
ds_read_b128 v[68:71], v253 offset:40960
ds_read_b128 v[72:75], v252 offset:45056
ds_read_b128 v[76:79], v253 offset:45056
v_pk_add_f32 v[16:17], v[16:17], v[24:25]
v_pk_add_f32 v[40:41], v[24:25], v[40:41] neg_lo:[0,1] neg_hi:[0,1]
v_pk_add_f32 v[16:17], v[16:17], v[32:33]
v_pk_add_f32 v[40:41], v[40:41], v[32:33] neg_lo:[0,1] neg_hi:[0,1]
v_pk_fma_f32 v[238:239], v[16:17], s[28:29], v[238:239]
v_pk_fma_f32 v[240:241], v[40:41], s[28:29], v[240:241]
v_cvt_pk_bf16_f32 v120, v238, v239
v_cvt_pk_bf16_f32 v124, v240, v241
v_lshlrev_b32 v242, 16, v153
v_and_b32 v243, 0xffff0000, v153
v_lshlrev_b32 v244, 16, v157
v_and_b32 v245, 0xffff0000, v157
v_pk_add_f32 v[18:19], v[18:19], v[26:27]
v_pk_add_f32 v[42:43], v[26:27], v[42:43] neg_lo:[0,1] neg_hi:[0,1]
v_pk_add_f32 v[18:19], v[18:19], v[34:35]
v_pk_add_f32 v[42:43], v[42:43], v[34:35] neg_lo:[0,1] neg_hi:[0,1]
v_pk_fma_f32 v[242:243], v[18:19], s[28:29], v[242:243]
v_pk_fma_f32 v[244:245], v[42:43], s[28:29], v[244:245]
v_cvt_pk_bf16_f32 v121, v242, v243
v_cvt_pk_bf16_f32 v125, v244, v245
v_lshlrev_b32 v238, 16, v154
v_and_b32 v239, 0xffff0000, v154
v_lshlrev_b32 v240, 16, v158
v_and_b32 v241, 0xffff0000, v158
v_pk_add_f32 v[20:21], v[20:21], v[28:29]
v_pk_add_f32 v[44:45], v[28:29], v[44:45] neg_lo:[0,1] neg_hi:[0,1]
v_pk_add_f32 v[20:21], v[20:21], v[36:37]
v_pk_add_f32 v[44:45], v[44:45], v[36:37] neg_lo:[0,1] neg_hi:[0,1]
v_pk_fma_f32 v[238:239], v[20:21], s[28:29], v[238:239]
v_pk_fma_f32 v[240:241], v[44:45], s[28:29], v[240:241]
v_cvt_pk_bf16_f32 v122, v238, v239
v_cvt_pk_bf16_f32 v126, v240, v241
v_lshlrev_b32 v242, 16, v155
v_and_b32 v243, 0xffff0000, v155
v_lshlrev_b32 v244, 16, v159
v_and_b32 v245, 0xffff0000, v159
v_pk_add_f32 v[22:23], v[22:23], v[30:31]
v_pk_add_f32 v[46:47], v[30:31], v[46:47] neg_lo:[0,1] neg_hi:[0,1]
v_pk_add_f32 v[22:23], v[22:23], v[38:39]
v_pk_add_f32 v[46:47], v[46:47], v[38:39] neg_lo:[0,1] neg_hi:[0,1]
v_pk_fma_f32 v[242:243], v[22:23], s[28:29], v[242:243]
v_pk_fma_f32 v[244:245], v[46:47], s[28:29], v[244:245]
v_cvt_pk_bf16_f32 v123, v242, v243
v_cvt_pk_bf16_f32 v127, v244, v245
buffer_store_dwordx4 v[120:123], v232, s[16:19], s34 offen sc1
buffer_store_dwordx4 v[124:127], v232, s[16:19], s34 offen offset:1024 sc1
s_waitcnt vmcnt(6)
v_lshlrev_b32 v238, 16, v160
v_and_b32 v239, 0xffff0000, v160
v_lshlrev_b32 v240, 16, v164
v_and_b32 v241, 0xffff0000, v164
s_waitcnt lgkmcnt(0)
v_pk_add_f32 v[48:49], v[48:49], v[56:57]
v_pk_add_f32 v[72:73], v[56:57], v[72:73] neg_lo:[0,1] neg_hi:[0,1]
v_pk_add_f32 v[48:49], v[48:49], v[64:65]
v_pk_add_f32 v[72:73], v[72:73], v[64:65] neg_lo:[0,1] neg_hi:[0,1]
v_pk_fma_f32 v[238:239], v[48:49], s[28:29], v[238:239]
v_pk_fma_f32 v[240:241], v[72:73], s[28:29], v[240:241]
v_cvt_pk_bf16_f32 v128, v238, v239
v_cvt_pk_bf16_f32 v132, v240, v241
v_lshlrev_b32 v242, 16, v161
v_and_b32 v243, 0xffff0000, v161
v_lshlrev_b32 v244, 16, v165
v_and_b32 v245, 0xffff0000, v165
v_pk_add_f32 v[50:51], v[50:51], v[58:59]
v_pk_add_f32 v[74:75], v[58:59], v[74:75] neg_lo:[0,1] neg_hi:[0,1]
v_pk_add_f32 v[50:51], v[50:51], v[66:67]
v_pk_add_f32 v[74:75], v[74:75], v[66:67] neg_lo:[0,1] neg_hi:[0,1]
v_pk_fma_f32 v[242:243], v[50:51], s[28:29], v[242:243]
v_pk_fma_f32 v[244:245], v[74:75], s[28:29], v[244:245]
v_cvt_pk_bf16_f32 v129, v242, v243
v_cvt_pk_bf16_f32 v133, v244, v245
v_lshlrev_b32 v238, 16, v162
v_and_b32 v239, 0xffff0000, v162
v_lshlrev_b32 v240, 16, v166
v_and_b32 v241, 0xffff0000, v166
v_pk_add_f32 v[52:53], v[52:53], v[60:61]
v_pk_add_f32 v[76:77], v[60:61], v[76:77] neg_lo:[0,1] neg_hi:[0,1]
v_pk_add_f32 v[52:53], v[52:53], v[68:69]
v_pk_add_f32 v[76:77], v[76:77], v[68:69] neg_lo:[0,1] neg_hi:[0,1]
v_pk_fma_f32 v[238:239], v[52:53], s[28:29], v[238:239]
v_pk_fma_f32 v[240:241], v[76:77], s[28:29], v[240:241]
v_cvt_pk_bf16_f32 v130, v238, v239
v_cvt_pk_bf16_f32 v134, v240, v241
v_lshlrev_b32 v242, 16, v163
v_and_b32 v243, 0xffff0000, v163
v_lshlrev_b32 v244, 16, v167
v_and_b32 v245, 0xffff0000, v167
v_pk_add_f32 v[54:55], v[54:55], v[62:63]
v_pk_add_f32 v[78:79], v[62:63], v[78:79] neg_lo:[0,1] neg_hi:[0,1]
v_pk_add_f32 v[54:55], v[54:55], v[70:71]
v_pk_add_f32 v[78:79], v[78:79], v[70:71] neg_lo:[0,1] neg_hi:[0,1]
v_pk_fma_f32 v[242:243], v[54:55], s[28:29], v[242:243]
v_pk_fma_f32 v[244:245], v[78:79], s[28:29], v[244:245]
v_cvt_pk_bf16_f32 v131, v242, v243
v_cvt_pk_bf16_f32 v135, v244, v245
buffer_store_dwordx4 v[128:131], v232, s[16:19], s35 offen sc1
buffer_store_dwordx4 v[132:135], v232, s[16:19], s35 offen offset:1024 sc1
cn_k2_kernel_end:
s_endpgm
cn_k2_kernel_fix:
s_waitcnt vmcnt(0)
s_mov_b64 s[80:81], -1
s_mov_b32 s66, s20
s_mov_b32 s67, s22
s_lshl_b32 s68, s2, 2
s_add_u32 s68, s68, s36
s_mul_i32 s20, s68, 229376
s_add_u32 s20, s20, 33554432
s_add_u32 s22, s20, 196608
s_mov_b32 s68, s20
v_readlane_b32 s69, v255, 1
s_nop 0
s_min_u32 s64, s64, s69
v_readlane_b32 s69, v255, 2
s_nop 0
s_min_u32 s64, s64, s69
v_readlane_b32 s69, v255, 3
s_nop 0
s_min_u32 s64, s64, s69
v_readlane_b32 s69, v255, 4
s_nop 0
s_min_u32 s64, s64, s69
v_readlane_b32 s69, v255, 5
s_nop 0
s_min_u32 s64, s64, s69
v_readlane_b32 s69, v255, 6
s_nop 0
s_min_u32 s64, s64, s69
v_readlane_b32 s69, v255, 7
s_nop 0
s_min_u32 s64, s64, s69
v_readlane_b32 s69, v255, 8
s_nop 0
s_min_u32 s64, s64, s69
v_readlane_b32 s69, v255, 9
s_nop 0
s_min_u32 s64, s64, s69
v_readlane_b32 s69, v255, 10
s_nop 0
s_min_u32 s64, s64, s69
v_readlane_b32 s69, v255, 11
s_nop 0
s_min_u32 s64, s64, s69
v_readlane_b32 s69, v255, 12
s_nop 0
s_min_u32 s64, s64, s69
v_readlane_b32 s69, v255, 13
s_nop 0
s_min_u32 s64, s64, s69
v_readlane_b32 s69, v255, 14
s_nop 0
s_min_u32 s64, s64, s69
v_readlane_b32 s69, v255, 15
s_nop 0
s_min_u32 s64, s64, s69
v_readlane_b32 s69, v255, 16
s_nop 0
s_min_u32 s64, s64, s69
v_readlane_b32 s69, v255, 17
s_nop 0
s_min_u32 s64, s64, s69
v_readlane_b32 s69, v255, 18
s_nop 0
s_min_u32 s64, s64, s69
v_readlane_b32 s69, v255, 19
s_nop 0
s_min_u32 s64, s64, s69
v_readlane_b32 s69, v255, 20
s_nop 0
s_min_u32 s64, s64, s69
v_readlane_b32 s69, v255, 21
s_nop 0
s_min_u32 s64, s64, s69
v_readlane_b32 s69, v255, 22
s_nop 0
s_min_u32 s64, s64, s69
v_readlane_b32 s69, v255, 23
s_nop 0
s_min_u32 s64, s64, s69
v_subrev_u32 v246, s64, v255
v_cmp_eq_u32 vcc, 0, v246
v_min_u32 v246, 0x3f000000, v246
v_sub_u32 v246, 0x3f800000, v246
s_ff1_i32_b64 s69, vcc
s_min_u32 s69, s69, 23
s_lshl_b32 s69, s69, 2
v_mov_b32 v254, s69
s_mov_b32 s70, 0
cn_k2_kernel_fixU:
s_mul_hi_u32 s71, s70, 0x55555556
s_mul_i32 s72, s71, 3
s_sub_u32 s72, s70, s72
s_lshr_b32 s71, s71, 1
s_lshl_b32 s72, s72, 3
s_add_u32 s71, s71, s72
s_nop 3
v_readlane_b32 s73, v246, s71
buffer_load_dwordx4 v[16:19], v1, s[8:11], s66 offen offset:0
buffer_load_dwordx4 v[20:23], v1, s[8:11], s66 offen offset:1024
buffer_load_dwordx4 v[24:27], v1, s[8:11], s66 offen offset:2048
buffer_load_dwordx4 v[28:31], v1, s[8:11], s66 offen offset:3072
v_cvt_f16_f32 v247, s73
s_nop 0
v_pack_b32_f16 v247, v247, v247
s_waitcnt vmcnt(0)
v_pk_mul_f16 v16, v16, v247
v_pk_mul_f16 v17, v17, v247
v_pk_mul_f16 v18, v18, v247
v_pk_mul_f16 v19, v19, v247
v_pk_mul_f16 v20, v20, v247
v_pk_mul_f16 v21, v21, v247
v_pk_mul_f16 v22, v22, v247
v_pk_mul_f16 v23, v23, v247
v_pk_mul_f16 v24, v24, v247
v_pk_mul_f16 v25, v25, v247
v_pk_mul_f16 v26, v26, v247
v_pk_mul_f16 v27, v27, v247
v_pk_mul_f16 v28, v28, v247
v_pk_mul_f16 v29, v29, v247
v_pk_mul_f16 v30, v30, v247
v_pk_mul_f16 v31, v31, v247
buffer_store_dwordx4 v[16:19], v1, s[8:11], s68 offen offset:0 sc1
buffer_store_dwordx4 v[20:23], v1, s[8:11], s68 offen offset:1024 sc1
buffer_store_dwordx4 v[24:27], v1, s[8:11], s68 offen offset:2048 sc1
buffer_store_dwordx4 v[28:31], v1, s[8:11], s68 offen offset:3072 sc1
s_waitcnt vmcnt(0)
s_add_u32 s66, s66, 4096
s_add_u32 s68, s68, 4096
s_add_u32 s70, s70, 1
s_cmp_lt_u32 s70, 48
s_cbranch_scc1 cn_k2_kernel_fixU
s_add_u32 s70, s36, 1
s_bfe_u32 s70, s70, 0x10001
s_lshl_b32 s70, s70, 3
s_add_u32 s74, s70, 8
cn_k2_kernel_fixZ:
s_lshr_b32 s71, s70, 1
s_add_u32 s71, s71, 8
s_nop 3
v_readlane_b32 s73, v246, s71
buffer_load_dwordx4 v[16:19], v1, s[8:11], s67 offen offset:0
buffer_load_dwordx4 v[20:23], v1, s[8:11], s67 offen offset:1024
buffer_load_dwordx4 v[24:27], v1, s[8:11], s67 offen offset:2048
buffer_load_dwordx4 v[28:31], v1, s[8:11], s67 offen offset:3072
s_waitcnt vmcnt(0)
v_lshlrev_b32 v247, 16, v16
v_and_b32 v248, 0xffff0000, v16
v_mul_f32 v247, s73, v247
v_mul_f32 v248, s73, v248
v_cvt_pk_bf16_f32 v16, v247, v248
v_lshlrev_b32 v247, 16, v17
v_and_b32 v248, 0xffff0000, v17
v_mul_f32 v247, s73, v247
v_mul_f32 v248, s73, v248
v_cvt_pk_bf16_f32 v17, v247, v248
v_lshlrev_b32 v247, 16, v18
v_and_b32 v248, 0xffff0000, v18
v_mul_f32 v247, s73, v247
v_mul_f32 v248, s73, v248
v_cvt_pk_bf16_f32 v18, v247, v248
v_lshlrev_b32 v247, 16, v19
v_and_b32 v248, 0xffff0000, v19
v_mul_f32 v247, s73, v247
v_mul_f32 v248, s73, v248
v_cvt_pk_bf16_f32 v19, v247, v248
v_lshlrev_b32 v247, 16, v20
v_and_b32 v248, 0xffff0000, v20
v_mul_f32 v247, s73, v247
v_mul_f32 v248, s73, v248
v_cvt_pk_bf16_f32 v20, v247, v248
v_lshlrev_b32 v247, 16, v21
v_and_b32 v248, 0xffff0000, v21
v_mul_f32 v247, s73, v247
v_mul_f32 v248, s73, v248
v_cvt_pk_bf16_f32 v21, v247, v248
v_lshlrev_b32 v247, 16, v22
v_and_b32 v248, 0xffff0000, v22
v_mul_f32 v247, s73, v247
v_mul_f32 v248, s73, v248
v_cvt_pk_bf16_f32 v22, v247, v248
v_lshlrev_b32 v247, 16, v23
v_and_b32 v248, 0xffff0000, v23
v_mul_f32 v247, s73, v247
v_mul_f32 v248, s73, v248
v_cvt_pk_bf16_f32 v23, v247, v248
v_lshlrev_b32 v247, 16, v24
v_and_b32 v248, 0xffff0000, v24
v_mul_f32 v247, s73, v247
v_mul_f32 v248, s73, v248
v_cvt_pk_bf16_f32 v24, v247, v248
v_lshlrev_b32 v247, 16, v25
v_and_b32 v248, 0xffff0000, v25
v_mul_f32 v247, s73, v247
v_mul_f32 v248, s73, v248
v_cvt_pk_bf16_f32 v25, v247, v248
v_lshlrev_b32 v247, 16, v26
v_and_b32 v248, 0xffff0000, v26
v_mul_f32 v247, s73, v247
v_mul_f32 v248, s73, v248
v_cvt_pk_bf16_f32 v26, v247, v248
v_lshlrev_b32 v247, 16, v27
v_and_b32 v248, 0xffff0000, v27
v_mul_f32 v247, s73, v247
v_mul_f32 v248, s73, v248
v_cvt_pk_bf16_f32 v27, v247, v248
v_lshlrev_b32 v247, 16, v28
v_and_b32 v248, 0xffff0000, v28
v_mul_f32 v247, s73, v247
v_mul_f32 v248, s73, v248
v_cvt_pk_bf16_f32 v28, v247, v248
v_lshlrev_b32 v247, 16, v29
v_and_b32 v248, 0xffff0000, v29
v_mul_f32 v247, s73, v247
v_mul_f32 v248, s73, v248
v_cvt_pk_bf16_f32 v29, v247, v248
v_lshlrev_b32 v247, 16, v30
v_and_b32 v248, 0xffff0000, v30
v_mul_f32 v247, s73, v247
v_mul_f32 v248, s73, v248
v_cvt_pk_bf16_f32 v30, v247, v248
v_lshlrev_b32 v247, 16, v31
v_and_b32 v248, 0xffff0000, v31
v_mul_f32 v247, s73, v247
v_mul_f32 v248, s73, v248
v_cvt_pk_bf16_f32 v31, v247, v248
buffer_store_dwordx4 v[16:19], v1, s[8:11], s68 offen offset:0 sc1
buffer_store_dwordx4 v[20:23], v1, s[8:11], s68 offen offset:1024 sc1
buffer_store_dwordx4 v[24:27], v1, s[8:11], s68 offen offset:2048 sc1
buffer_store_dwordx4 v[28:31], v1, s[8:11], s68 offen offset:3072 sc1
s_waitcnt vmcnt(0)
s_add_u32 s67, s67, 4096
s_add_u32 s68, s68, 4096
s_add_u32 s70, s70, 1
s_cmp_lt_u32 s70, s74
s_cbranch_scc1 cn_k2_kernel_fixZ
s_mul_i32 s25, s36, 5440
s_add_u32 s25, s25, 0x10000
s_branch cn_k2_kernel_reload
.section .rodata,"a"
.p2align 6
.amdhsa_kernel cn_k2_kernel
  .amdhsa_next_free_vgpr 512
  .amdhsa_next_free_sgpr 102
  .amdhsa_accum_offset 256
  .amdhsa_group_segment_fixed_size 0
  .amdhsa_kernarg_size 72
  .amdhsa_user_sgpr_count 2
  .amdhsa_user_sgpr_kernarg_segment_ptr 1
  .amdhsa_system_sgpr_workgroup_id_x 1
.end_amdhsa_kernel
.text
cn_code_end:
s_endpgm
```
